```python
import torch

def _softmax(x, axis=-1):
    return torch.softmax(x, dim=axis)
def _gelu(x):
    return torch.nn.functional.gelu(x, approximate="tanh")
def _silu(x):
    return torch.nn.functional.silu(x)
def _sigmoid(x):
    return torch.sigmoid(x)
def _layernorm(x, axis=-1, eps=1e-5):
    m = x.mean(dim=axis, keepdim=True)
    v = x.var(dim=axis, keepdim=True, unbiased=False)
    return (x - m) / torch.sqrt(v + eps)
def _scatter_add(tgt, idx, src, axis=0):
    return tgt.clone().index_add_(axis, idx, src)
def _segment_sum(src, seg, n):
    out = torch.zeros((n,) + src.shape[1:], dtype=src.dtype)
    return out.index_add_(0, seg, src)
def _pad(x, pw):
    flat = tuple(v for pair in reversed(pw) for v in pair)
    return torch.nn.functional.pad(x, flat)

kernel_name = 'recurrent_scan__ssm_conv_s4d__moe_arch_mod__prompt'

def setup_inputs():

    _w = (lambda a: (lambda t: t.to(torch.bfloat16) if t.is_floating_point() else t)(torch.as_tensor(a)))
    def _A_setup():
        Bsz, L, D, N = 1, 2048, 640, 128
        return {
            "u": _w((lambda *s: torch.randn(*s, dtype=torch.bfloat16) * 0.05)(Bsz, L, D)),
            "log_A_real": _w((lambda *s: torch.randn(*s, dtype=torch.bfloat16) * 6.4)(D, N) * 0.5),
            "A_imag": _w((lambda *s: torch.randn(*s, dtype=torch.bfloat16) * 0.05)(D, N) * 3.14),
            "C_real": _w((lambda *s: torch.randn(*s, dtype=torch.bfloat16) * 0.05)(D, N) / N ** 0.5),
            "C_imag": _w((lambda *s: torch.randn(*s, dtype=torch.bfloat16) * 0.05)(D, N) / N ** 0.5),
            "log_dt": _w((lambda *s: torch.randn(*s, dtype=torch.bfloat16) * 0.05)(D) * 0.5 - 4.0),
            "D_skip": _w((lambda *s: torch.randn(*s, dtype=torch.bfloat16) * 0.05)(D)),
        }
    _A_in = _A_setup()

    def _B_setup():
        B, S, D, F, C = 1, 2048, 640, 1728, 8
        return {
            "x": _w((lambda *s: torch.randn(*s, dtype=torch.bfloat16) * 0.05)(B, S, D)),
            "w_r": _w((lambda *s: torch.randn(*s, dtype=torch.bfloat16) * 0.05)(D)),
            "w_gate": _w((lambda *s: torch.randn(*s, dtype=torch.bfloat16) * 0.05)(D, F)),
            "w_up": _w((lambda *s: torch.randn(*s, dtype=torch.bfloat16) * 0.05)(D, F)),
            "w_down": _w((lambda *s: torch.randn(*s, dtype=torch.bfloat16) * 0.05)(F, D)),
        }
    _B_in = _B_setup()

    return {
        "A_u": _A_in["u"],
        "A_log_A_real": _A_in["log_A_real"],
        "A_A_imag": _A_in["A_imag"],
        "A_C_real": _A_in["C_real"],
        "A_C_imag": _A_in["C_imag"],
        "A_log_dt": _A_in["log_dt"],
        "A_D_skip": _A_in["D_skip"],
        "B_x": _B_in["x"],
        "B_w_r": _B_in["w_r"],
        "B_w_gate": _B_in["w_gate"],
        "B_w_up": _B_in["w_up"],
        "B_w_down": _B_in["w_down"],
    }

def reference(A_u, A_log_A_real, A_A_imag, A_C_real, A_C_imag, A_log_dt, A_D_skip, B_x, B_w_r, B_w_gate, B_w_up, B_w_down):
    def _A_ref(u, log_A_real, A_imag, C_real, C_imag, log_dt, D_skip):
        L = u.shape[1]
        dt = torch.exp(log_dt)
        A = -torch.exp(log_A_real) + 1j * A_imag
        C = (C_real + 1j * C_imag) * dt[:, None]
        pos = (lambda x, dt: x.to(dt))(torch.arange(L), log_dt.dtype)
        P = torch.exp((A * dt[:, None])[:, :, None] * pos[None, None, :])
        K = 2.0 * torch.einsum("dn,dnl->dl", C, P).real
        L2 = 2 * L
        u_t = (lambda x, *d: x.permute(*d))(u, 0, 2, 1)
        Kf = (lambda x, *a, **k: torch.fft.rfft(x.float(), *a, **k))(K, L2)
        Uf = (lambda x, *a, **k: torch.fft.rfft(x.float(), *a, **k))(u_t, L2)
        y = (lambda x, *a, **k: torch.fft.irfft(x, *a, **k).to(torch.bfloat16))(Uf * Kf[None, :, :], L2)[:, :, :L]
        y = (lambda x, *d: x.permute(*d))(y, 0, 2, 1)
        return y + u * D_skip[None, None, :]

    def _B_ref(x, w_r, w_gate, w_up, w_down):
        B, S, D = x.shape
        C = 8
        r = x @ w_r
        idx = torch.argsort(-r, axis=-1)[:, :C]
        idx_e = (lambda x, n, axis: torch.repeat_interleave(x, n, dim=axis))(idx.reshape(B, C, 1), D, axis=2)
        x_sel = (lambda x, i, axis: torch.take_along_dim(x, i, dim=axis))(x, idx_e, axis=1)
        g = _silu(x_sel @ w_gate)
        u = x_sel @ w_up
        y = (g * u) @ w_down
        r_sel = _sigmoid((lambda x, i, axis: torch.take_along_dim(x, i, dim=axis))(r, idx, axis=1))
        y = y * r_sel.reshape(B, C, 1)
        b_off = (torch.arange(B) * S).reshape(B, 1)
        flat_idx = (idx + b_off).reshape(B * C)
        zero = (x * 0.0).reshape(B * S, D)
        upd = _scatter_add(zero, flat_idx, y.reshape(B * C, D), axis=0)
        return x + upd.reshape(B, S, D)

    x = A_u
    xn = _layernorm(x, axis=-1)
    s = _A_ref(xn, A_log_A_real, A_A_imag, A_C_real, A_C_imag, A_log_dt, A_D_skip)
    g = _silu(_B_ref(xn, B_w_r, B_w_gate, B_w_up, B_w_down))
    return x + s * g
```

```asm
; @launch grid=(256,1,1) block=(512,1,1) lds=163056
.amdgcn_target "amdgcn-amd-amdhsa--gfx950"
.text
.globl recurrent_scan__ssm_conv_s4d__moe_arch_mod__prompt_kernel
.p2align 8
.type recurrent_scan__ssm_conv_s4d__moe_arch_mod__prompt_kernel,@function
recurrent_scan__ssm_conv_s4d__moe_arch_mod__prompt_kernel:
    s_cmp_ge_u32 s2, 256
    s_cbranch_scc1 L_end
    s_load_dwordx16 s[16:31], s[0:1], 0
    s_load_dwordx8 s[32:39], s[0:1], 64
    s_load_dwordx2 s[40:41], s[0:1], 96
    s_load_dwordx2 s[42:43], s[0:1], 112
    s_getpc_b64 s[6:7]
L_pc:
    s_lshr_b32 s8, s2, 3
    v_lshrrev_b32 v2, 6, v0
    s_lshl_b32 s5, s8, 10
    v_lshl_add_u32 v5, v0, 1, s5
    v_readfirstlane_b32 s3, v2
    v_min_u32 v5, L_code_end-L_pc, v5
    v_and_b32 v5, -4, v5
    global_load_dword v252, v5, s[6:7]
    v_and_b32 v1, 63, v0
    v_lshlrev_b32 v3, 4, v1
    v_lshlrev_b32 v4, 2, v1
    v_mov_b32 v32, 0
    v_mov_b32 v246, 160768
    v_mov_b32 v247, 1
    ds_write_b32 v246, v32 offset:2272
    s_and_b32 s45, s3, 3
    s_and_b32 s9, s2, 7
    s_lshl_b32 s10, s2, 3
    s_add_u32 s10, s10, s3
    s_mul_i32 s11, s10, 1280
    s_lshr_b32 s46, s3, 2
    s_mul_i32 s12, s9, 20
    s_add_u32 s44, s12, s8
    s_lshr_b32 s49, s3, 1
    s_lshr_b32 s5, s12, 4
    s_and_b32 s6, s3, 1
    s_add_u32 s5, s5, s6
    s_lshl_b32 s62, s5, 7
    s_lshl_b32 s6, s8, 2
    s_add_u32 s6, s6, s49
    s_mul_i32 s6, s6, 10240
    s_add_u32 s5, s62, s6
    v_mul_u32_u24 v93, 1280, v1
    v_add_u32 v22, s5, v93
    s_lshl_b32 s5, s49, 3
    s_add_u32 s5, s5, s9
    s_min_u32 s5, s5, 26
    s_lshl_b32 s5, s5, 7
    s_mul_i32 s6, s8, 69120
    s_add_u32 s5, s5, s6
    v_mul_u32_u24 v23, 3456, v1
    v_add_u32 v23, s5, v23
    s_lshl_b32 s5, s45, 8
    s_lshl_b32 s6, s46, 7
    s_add_u32 s5, s5, s6
    s_lshl_b32 s6, s44, 10
    s_add_u32 s5, s5, s6
    v_lshl_add_u32 v6, v1, 1, s5
    s_lshr_b32 s5, s5, 8
    s_lshl_b32 s5, s5, 1
    v_mov_b32 v7, s5
    s_waitcnt lgkmcnt(0)
    s_add_u32 s6, s16, s11
    s_addc_u32 s7, s17, 0
    global_load_dwordx4 v[8:11], v3, s[6:7]
    global_load_dword v12, v4, s[6:7] offset:1024
    global_load_dwordx4 v[16:19], v3, s[32:33]
    global_load_dword v20, v4, s[32:33] offset:1024
    global_load_dword v29, v32, s[42:43]
    s_bitcmp1_b32 s3, 0
    s_cselect_b32 s56, s36, s34
    s_cselect_b32 s57, s37, s35
    s_barrier
    s_cmp_ge_u32 s2, 160
    s_cbranch_scc1 L_nopar
    global_load_ushort v40, v6, s[18:19]
    global_load_ushort v45, v7, s[26:27]
    global_load_ushort v41, v6, s[20:21]
    global_load_ushort v42, v6, s[22:23]
    global_load_ushort v43, v6, s[24:25]
    global_load_ushort v46, v7, s[28:29]
L_nopar:
    s_barrier
    s_bfm_b64 exec, 8, 0
    global_load_dword v251, v22, s[16:17]
    s_mov_b64 exec, -1
    v_mov_b32 v33, 0
    v_mov_b32 v34, 0
    v_mov_b32 v35, 0
    s_cbranch_scc1 L_notconv
    s_and_b32 s6, s8, 15
    s_lshl_b32 s6, s6, 1
    s_and_b32 s7, s49, 1
    s_add_u32 s6, s6, s7
    s_add_u32 s6, s6, 32
    s_mul_i32 s6, s6, 40960
    s_add_u32 s5, s62, s6
    v_add_u32 v93, s5, v93
    v_mov_b32 v33, 0
    v_mov_b32 v34, 0
    v_mov_b32 v35, 0
    v_lshlrev_b32 v7, 4, v0
    v_add_u32 v7, 135040, v7
    ds_write_b128 v7, v[32:35]
    ds_write_b128 v7, v[32:35] offset:8192
    ds_write_b128 v7, v[32:35] offset:16384
    v_min_u32 v7, 138448, v7
    ds_write_b128 v7, v[32:35] offset:24576
    s_mul_i32 s53, s45, 4608
    s_add_u32 s53, s53, 115584
    v_lshl_add_u32 v7, v1, 3, s53
    ds_write_b64 v7, v[32:33]
    s_add_u32 s5, s45, 1
    s_sub_u32 s13, s5, 32
    s_lshl_b32 s5, s5, 1
    v_add_u32 v36, s13, v1
    v_add_u32 v92, 1, v36
    v_mov_b32 v38, 0x3f800000
    v_mov_b32 v39, 0x3f80
    v_cmp_ge_u32 s[6:7], s5, v36
    v_cmp_ge_u32 s[14:15], s5, v92
    s_lshl_b32 s13, s45, 8
    s_add_u32 s13, s13, 134016
    v_cndmask_b32 v38, 0, v38, s[6:7]
    v_cndmask_b32 v39, 0, v39, s[14:15]
    v_add_u32 v7, s13, v4
    v_or_b32 v38, v38, v39
    ds_write_b32 v7, v38
    v_and_b32 v2, 15, v1
    v_lshrrev_b32 v92, 4, v1
    v_lshlrev_b32 v92, 3, v92
    v_sub_u32 v92, v2, v92
    v_lshlrev_b32 v92, 2, v92
    v_add_u32 v92, 134112, v92
    s_mul_i32 s5, s45, 327680
    s_lshl_b32 s6, s44, 3
    s_add_u32 s5, s5, s6
    v_mul_u32_u24 v94, 5120, v1
    v_add_u32 v94, s5, v94
    s_lshl_b32 s55, s45, 1
    s_sub_u32 s55, 7, s55
    s_mul_i32 s5, s55, 327680
    v_add_u32 v95, s5, v94
    s_lshl_b32 s5, s45, 9
    s_lshl_b32 s6, s46, 8
    s_add_u32 s50, s5, s6
    s_add_u32 s51, s50, 49536
    s_mov_b32 m0, s51
    v_mov_b32 v84, 0x3f80
    v_mov_b32 v44, 0x3fb8aa3b
    s_lshr_b32 s63, s3, 2
    s_mov_b64 exec, 0xfffff
    global_load_dword v251, v23, s[56:57]
    s_mov_b64 exec, -1
    s_mov_b32 s14, 0x9E3779B1
    s_mov_b32 s47, 0x3f803f80
    s_lshl_b32 s11, s10, 3
    s_sub_u32 s13, 2047, s10
    v_mov_b32 v33, s11
    v_add_u32 v34, 4096, v33
    v_lshlrev_b32 v35, 1, v33
    v_add_u32 v35, 20480, v35
    v_mov_b32 v36, 0x3acccccd
    s_waitcnt vmcnt(8)
    s_setprio 2
    v_dot2_f32_bf16 v24, v8, s47, 0
    v_dot2_f32_bf16 v25, v8, v8, 0
    v_dot2_f32_bf16 v26, v8, v16, 0
    v_dot2_f32_bf16 v27, v16, s47, 0
    v_dot2_f32_bf16 v24, v9, s47, v24
    v_dot2_f32_bf16 v25, v9, v9, v25
    v_dot2_f32_bf16 v26, v9, v17, v26
    v_dot2_f32_bf16 v27, v17, s47, v27
    v_dot2_f32_bf16 v24, v10, s47, v24
    v_dot2_f32_bf16 v25, v10, v10, v25
    v_dot2_f32_bf16 v26, v10, v18, v26
    v_dot2_f32_bf16 v27, v18, s47, v27
    v_dot2_f32_bf16 v24, v11, s47, v24
    v_dot2_f32_bf16 v25, v11, v11, v25
    v_dot2_f32_bf16 v26, v11, v19, v26
    v_dot2_f32_bf16 v27, v19, s47, v27
    v_dot2_f32_bf16 v24, v12, s47, v24
    v_dot2_f32_bf16 v25, v12, v12, v25
    v_dot2_f32_bf16 v26, v12, v20, v26
    v_dot2_f32_bf16 v27, v20, s47, v27
    s_nop 0
    v_permlane32_swap_b32 v24, v25
    s_nop 0
    v_permlane32_swap_b32 v26, v27
    v_add_f32 v24, v24, v25
    v_add_f32 v26, v26, v27
    s_nop 0
    v_mul_lo_u32 v29, v29, s14
    v_permlane16_swap_b32 v24, v26
    v_add_f32 v24, v24, v26
    v_add_u32 v29, 0x7F4A7C15, v29
    v_mov_b32 v31, v29
    v_add_f32_dpp v24, v24, v24 row_shr:1 row_mask:0xf bank_mask:0xf bound_ctrl:0
    v_readfirstlane_b32 s4, v29
    s_nop 0
    v_add_f32_dpp v24, v24, v24 row_shr:2 row_mask:0xf bank_mask:0xf bound_ctrl:0
    s_nop 1
    v_add_f32_dpp v24, v24, v24 row_shr:4 row_mask:0xf bank_mask:0xf bound_ctrl:0
    s_nop 1
    v_add_f32_dpp v24, v24, v24 row_shr:8 row_mask:0xf bank_mask:0xf bound_ctrl:0
    s_mov_b64 exec, 1
    v_readlane_b32 s6, v24, 15
    v_readlane_b32 s7, v24, 47
    v_readlane_b32 s14, v24, 31
    v_readlane_b32 s15, v24, 63
    v_mul_f32 v24, s6, v36
    v_mul_f32 v25, s7, v36
    v_mov_b32 v26, s14
    v_fma_f32 v25, -v24, v24, v25
    v_max_f32 v25, 0, v25
    v_cvt_pk_bf16_f32 v28, v24, v25
    v_and_b32 v25, 0xffff0000, v28
    v_lshlrev_b32 v24, 16, v28
    v_add_f32 v25, 0x3727c5ac, v25
    v_cvt_pk_bf16_f32 v25, v25, v25
    v_fma_f32 v26, -v24, s15, v26
    v_and_b32 v25, 0xffff0000, v25
    v_sqrt_f32 v25, v25
    s_nop 0
    v_cvt_pk_bf16_f32 v28, v24, v25
    v_and_b32 v25, 0xffff0000, v28
    v_rcp_f32 v25, v25
    global_store_dwordx2 v34, v[28:29], s[42:43] sc1
    v_mul_f32 v26, v26, v25
    v_cvt_pk_bf16_f32 v26, v26, v26
    v_ashrrev_i32 v27, 31, v26
    v_or_b32 v27, 0x80000000, v27
    v_xor_b32 v26, v26, v27
    v_and_b32 v26, 0xffff0000, v26
    v_or_b32 v30, s13, v26
    global_store_dwordx4 v35, v[28:31], s[42:43] sc1
    ds_add_u32 v246, v247 offset:2272
    s_mov_b64 exec, -1
    s_setprio 0
    s_waitcnt vmcnt(4)
    v_lshlrev_b32 v40, 16, v40
    v_lshlrev_b32 v45, 16, v45
    v_mul_f32 v40, v44, v40
    v_mul_f32 v44, v45, v44
    v_exp_f32 v40, v40
    v_exp_f32 v44, v44
    v_lshlrev_b32 v41, 16, v41
    v_lshlrev_b32 v42, 16, v42
    v_cvt_pk_bf16_f32 v40, v44, v40
    v_lshlrev_b32 v43, 16, v43
    v_lshlrev_b32 v44, 16, v40
    v_and_b32 v40, 0xffff0000, v40
    v_mul_f32 v41, v41, v44
    v_mul_f32 v40, v40, v44
    v_add_f32 v44, v44, v44
    v_mul_f32 v40, 0xbfb8aa3b, v40
    v_mul_f32 v41, 0x3e22f983, v41
    v_mul_f32 v48, v42, v44
    v_mul_f32 v49, v43, v44
    v_mul_f32 v56, 0x41000000, v40
    v_mul_f32 v58, 0x41000000, v41
    v_mul_f32 v57, 0x43800000, v40
    v_mul_f32 v59, 0x43800000, v41
    v_fract_f32 v58, v58
    v_fract_f32 v60, v41
    v_fract_f32 v59, v59
    v_exp_f32 v56, v56
    v_cos_f32 v52, v58
    v_sin_f32 v53, v58
    v_exp_f32 v61, v40
    v_cos_f32 v50, v60
    v_sin_f32 v51, v60
    v_exp_f32 v57, v57
    v_cos_f32 v54, v59
    v_sin_f32 v55, v59
    ds_read_b32 v250, v246 offset:2272
    v_mul_f32 v52, v52, v56
    v_mul_f32_e64 v53, -v53, v56
    v_mul_f32 v50, v50, v61
    v_mul_f32 v51, v51, v61
    v_mul_f32 v54, v54, v57
    v_mul_f32 v55, v55, v57
    s_cmp_eq_u32 s63, 0
    s_cbranch_scc1 L_gc_1
    s_waitcnt lgkmcnt(0)
    v_readfirstlane_b32 s5, v250
    s_cmp_lt_u32 s5, 8
    s_cbranch_scc1 L_gc_1
    s_mov_b32 s63, 0
    global_load_dwordx2 v[96:97], v94, s[16:17] offset:0
    global_load_dwordx2 v[98:99], v94, s[16:17] offset:1280
    global_load_dwordx2 v[100:101], v94, s[16:17] offset:2560
    global_load_dwordx2 v[102:103], v94, s[16:17] offset:3840
L_gc_1:
    ds_write_addtid_b32 v84 offset:0
    v_cvt_pk_bf16_f32 v85, v52, v53
    ds_write_addtid_b32 v85 offset:2064
    ds_read_b32 v250, v246 offset:2272
    v_pk_mul_f32 v[64:65], v[52:53], v[52:53] op_sel:[0,0] op_sel_hi:[1,0]
    v_pk_fma_f32 v[64:65], v[52:53], v[52:53], v[64:65] op_sel:[1,1,0] op_sel_hi:[0,1,1] neg_lo:[1,0,0]
    v_cvt_pk_bf16_f32 v84, v64, v65
    ds_write_addtid_b32 v84 offset:4128
    v_pk_mul_f32 v[66:67], v[64:65], v[52:53] op_sel:[0,0] op_sel_hi:[1,0]
    v_pk_fma_f32 v[66:67], v[64:65], v[52:53], v[66:67] op_sel:[1,1,0] op_sel_hi:[0,1,1] neg_lo:[1,0,0]
    v_cvt_pk_bf16_f32 v85, v66, v67
    ds_write_addtid_b32 v85 offset:6192
    v_pk_mul_f32 v[64:65], v[66:67], v[52:53] op_sel:[0,0] op_sel_hi:[1,0]
    v_pk_fma_f32 v[64:65], v[66:67], v[52:53], v[64:65] op_sel:[1,1,0] op_sel_hi:[0,1,1] neg_lo:[1,0,0]
    v_cvt_pk_bf16_f32 v84, v64, v65
    ds_write_addtid_b32 v84 offset:8256
    s_cmp_eq_u32 s63, 0
    s_cbranch_scc1 L_gc_2
    s_waitcnt lgkmcnt(3)
    v_readfirstlane_b32 s5, v250
    s_cmp_lt_u32 s5, 8
    s_cbranch_scc1 L_gc_2
    s_mov_b32 s63, 0
    global_load_dwordx2 v[96:97], v94, s[16:17] offset:0
    global_load_dwordx2 v[98:99], v94, s[16:17] offset:1280
    global_load_dwordx2 v[100:101], v94, s[16:17] offset:2560
    global_load_dwordx2 v[102:103], v94, s[16:17] offset:3840
L_gc_2:
    v_pk_mul_f32 v[66:67], v[64:65], v[52:53] op_sel:[0,0] op_sel_hi:[1,0]
    v_pk_fma_f32 v[66:67], v[64:65], v[52:53], v[66:67] op_sel:[1,1,0] op_sel_hi:[0,1,1] neg_lo:[1,0,0]
    v_cvt_pk_bf16_f32 v85, v66, v67
    ds_write_addtid_b32 v85 offset:10320
    ds_read_b32 v250, v246 offset:2272
    v_pk_mul_f32 v[64:65], v[66:67], v[52:53] op_sel:[0,0] op_sel_hi:[1,0]
    v_pk_fma_f32 v[64:65], v[66:67], v[52:53], v[64:65] op_sel:[1,1,0] op_sel_hi:[0,1,1] neg_lo:[1,0,0]
    v_cvt_pk_bf16_f32 v84, v64, v65
    ds_write_addtid_b32 v84 offset:12384
    v_pk_mul_f32 v[66:67], v[64:65], v[52:53] op_sel:[0,0] op_sel_hi:[1,0]
    v_pk_fma_f32 v[66:67], v[64:65], v[52:53], v[66:67] op_sel:[1,1,0] op_sel_hi:[0,1,1] neg_lo:[1,0,0]
    v_cvt_pk_bf16_f32 v85, v66, v67
    ds_write_addtid_b32 v85 offset:14448
    v_pk_mul_f32 v[64:65], v[66:67], v[52:53] op_sel:[0,0] op_sel_hi:[1,0]
    v_pk_fma_f32 v[64:65], v[66:67], v[52:53], v[64:65] op_sel:[1,1,0] op_sel_hi:[0,1,1] neg_lo:[1,0,0]
    v_cvt_pk_bf16_f32 v84, v64, v65
    ds_write_addtid_b32 v84 offset:16512
    s_cmp_eq_u32 s63, 0
    s_cbranch_scc1 L_gc_3
    s_waitcnt lgkmcnt(3)
    v_readfirstlane_b32 s5, v250
    s_cmp_lt_u32 s5, 8
    s_cbranch_scc1 L_gc_3
    s_mov_b32 s63, 0
    global_load_dwordx2 v[96:97], v94, s[16:17] offset:0
    global_load_dwordx2 v[98:99], v94, s[16:17] offset:1280
    global_load_dwordx2 v[100:101], v94, s[16:17] offset:2560
    global_load_dwordx2 v[102:103], v94, s[16:17] offset:3840
L_gc_3:
    v_pk_mul_f32 v[66:67], v[64:65], v[52:53] op_sel:[0,0] op_sel_hi:[1,0]
    v_pk_fma_f32 v[66:67], v[64:65], v[52:53], v[66:67] op_sel:[1,1,0] op_sel_hi:[0,1,1] neg_lo:[1,0,0]
    v_cvt_pk_bf16_f32 v85, v66, v67
    ds_write_addtid_b32 v85 offset:18576
    ds_read_b32 v250, v246 offset:2272
    v_pk_mul_f32 v[64:65], v[66:67], v[52:53] op_sel:[0,0] op_sel_hi:[1,0]
    v_pk_fma_f32 v[64:65], v[66:67], v[52:53], v[64:65] op_sel:[1,1,0] op_sel_hi:[0,1,1] neg_lo:[1,0,0]
    v_cvt_pk_bf16_f32 v84, v64, v65
    ds_write_addtid_b32 v84 offset:20640
    v_pk_mul_f32 v[66:67], v[64:65], v[52:53] op_sel:[0,0] op_sel_hi:[1,0]
    v_pk_fma_f32 v[66:67], v[64:65], v[52:53], v[66:67] op_sel:[1,1,0] op_sel_hi:[0,1,1] neg_lo:[1,0,0]
    v_cvt_pk_bf16_f32 v85, v66, v67
    ds_write_addtid_b32 v85 offset:22704
    v_pk_mul_f32 v[64:65], v[66:67], v[52:53] op_sel:[0,0] op_sel_hi:[1,0]
    v_pk_fma_f32 v[64:65], v[66:67], v[52:53], v[64:65] op_sel:[1,1,0] op_sel_hi:[0,1,1] neg_lo:[1,0,0]
    v_cvt_pk_bf16_f32 v84, v64, v65
    ds_write_addtid_b32 v84 offset:24768
    s_cmp_eq_u32 s63, 0
    s_cbranch_scc1 L_gc_4
    s_waitcnt lgkmcnt(3)
    v_readfirstlane_b32 s5, v250
    s_cmp_lt_u32 s5, 8
    s_cbranch_scc1 L_gc_4
    s_mov_b32 s63, 0
    global_load_dwordx2 v[96:97], v94, s[16:17] offset:0
    global_load_dwordx2 v[98:99], v94, s[16:17] offset:1280
    global_load_dwordx2 v[100:101], v94, s[16:17] offset:2560
    global_load_dwordx2 v[102:103], v94, s[16:17] offset:3840
L_gc_4:
    v_pk_mul_f32 v[66:67], v[64:65], v[52:53] op_sel:[0,0] op_sel_hi:[1,0]
    v_pk_fma_f32 v[66:67], v[64:65], v[52:53], v[66:67] op_sel:[1,1,0] op_sel_hi:[0,1,1] neg_lo:[1,0,0]
    v_cvt_pk_bf16_f32 v85, v66, v67
    ds_write_addtid_b32 v85 offset:26832
    ds_read_b32 v250, v246 offset:2272
    v_pk_mul_f32 v[64:65], v[66:67], v[52:53] op_sel:[0,0] op_sel_hi:[1,0]
    v_pk_fma_f32 v[64:65], v[66:67], v[52:53], v[64:65] op_sel:[1,1,0] op_sel_hi:[0,1,1] neg_lo:[1,0,0]
    v_cvt_pk_bf16_f32 v84, v64, v65
    ds_write_addtid_b32 v84 offset:28896
    v_pk_mul_f32 v[66:67], v[64:65], v[52:53] op_sel:[0,0] op_sel_hi:[1,0]
    v_pk_fma_f32 v[66:67], v[64:65], v[52:53], v[66:67] op_sel:[1,1,0] op_sel_hi:[0,1,1] neg_lo:[1,0,0]
    v_cvt_pk_bf16_f32 v85, v66, v67
    ds_write_addtid_b32 v85 offset:30960
    v_pk_mul_f32 v[64:65], v[66:67], v[52:53] op_sel:[0,0] op_sel_hi:[1,0]
    v_pk_fma_f32 v[64:65], v[66:67], v[52:53], v[64:65] op_sel:[1,1,0] op_sel_hi:[0,1,1] neg_lo:[1,0,0]
    v_cvt_pk_bf16_f32 v84, v64, v65
    ds_write_addtid_b32 v84 offset:33024
    s_cmp_eq_u32 s63, 0
    s_cbranch_scc1 L_gc_5
    s_waitcnt lgkmcnt(3)
    v_readfirstlane_b32 s5, v250
    s_cmp_lt_u32 s5, 8
    s_cbranch_scc1 L_gc_5
    s_mov_b32 s63, 0
    global_load_dwordx2 v[96:97], v94, s[16:17] offset:0
    global_load_dwordx2 v[98:99], v94, s[16:17] offset:1280
    global_load_dwordx2 v[100:101], v94, s[16:17] offset:2560
    global_load_dwordx2 v[102:103], v94, s[16:17] offset:3840
L_gc_5:
    v_pk_mul_f32 v[66:67], v[64:65], v[52:53] op_sel:[0,0] op_sel_hi:[1,0]
    v_pk_fma_f32 v[66:67], v[64:65], v[52:53], v[66:67] op_sel:[1,1,0] op_sel_hi:[0,1,1] neg_lo:[1,0,0]
    v_cvt_pk_bf16_f32 v85, v66, v67
    ds_write_addtid_b32 v85 offset:35088
    v_pk_mul_f32 v[64:65], v[66:67], v[52:53] op_sel:[0,0] op_sel_hi:[1,0]
    v_pk_fma_f32 v[64:65], v[66:67], v[52:53], v[64:65] op_sel:[1,1,0] op_sel_hi:[0,1,1] neg_lo:[1,0,0]
    v_cvt_pk_bf16_f32 v84, v64, v65
    ds_write_addtid_b32 v84 offset:37152
    ds_read_b32 v250, v246 offset:2272
    v_pk_mul_f32 v[66:67], v[64:65], v[52:53] op_sel:[0,0] op_sel_hi:[1,0]
    v_pk_fma_f32 v[66:67], v[64:65], v[52:53], v[66:67] op_sel:[1,1,0] op_sel_hi:[0,1,1] neg_lo:[1,0,0]
    v_cvt_pk_bf16_f32 v85, v66, v67
    ds_write_addtid_b32 v85 offset:39216
    v_pk_mul_f32 v[64:65], v[66:67], v[52:53] op_sel:[0,0] op_sel_hi:[1,0]
    v_pk_fma_f32 v[64:65], v[66:67], v[52:53], v[64:65] op_sel:[1,1,0] op_sel_hi:[0,1,1] neg_lo:[1,0,0]
    v_cvt_pk_bf16_f32 v84, v64, v65
    ds_write_addtid_b32 v84 offset:41280
    v_pk_mul_f32 v[66:67], v[64:65], v[52:53] op_sel:[0,0] op_sel_hi:[1,0]
    v_pk_fma_f32 v[66:67], v[64:65], v[52:53], v[66:67] op_sel:[1,1,0] op_sel_hi:[0,1,1] neg_lo:[1,0,0]
    v_cvt_pk_bf16_f32 v85, v66, v67
    ds_write_addtid_b32 v85 offset:43344
    s_cmp_eq_u32 s63, 0
    s_cbranch_scc1 L_gc_6
    s_waitcnt lgkmcnt(3)
    v_readfirstlane_b32 s5, v250
    s_cmp_lt_u32 s5, 8
    s_cbranch_scc1 L_gc_6
    s_mov_b32 s63, 0
    global_load_dwordx2 v[96:97], v94, s[16:17] offset:0
    global_load_dwordx2 v[98:99], v94, s[16:17] offset:1280
    global_load_dwordx2 v[100:101], v94, s[16:17] offset:2560
    global_load_dwordx2 v[102:103], v94, s[16:17] offset:3840
L_gc_6:
    v_pk_mul_f32 v[64:65], v[66:67], v[52:53] op_sel:[0,0] op_sel_hi:[1,0]
    v_pk_fma_f32 v[64:65], v[66:67], v[52:53], v[64:65] op_sel:[1,1,0] op_sel_hi:[0,1,1] neg_lo:[1,0,0]
    v_cvt_pk_bf16_f32 v84, v64, v65
    ds_write_addtid_b32 v84 offset:45408
    v_pk_mul_f32 v[66:67], v[64:65], v[52:53] op_sel:[0,0] op_sel_hi:[1,0]
    v_pk_fma_f32 v[66:67], v[64:65], v[52:53], v[66:67] op_sel:[1,1,0] op_sel_hi:[0,1,1] neg_lo:[1,0,0]
    v_cvt_pk_bf16_f32 v85, v66, v67
    ds_write_addtid_b32 v85 offset:47472
    v_pk_mul_f32 v[64:65], v[66:67], v[52:53] op_sel:[0,0] op_sel_hi:[1,0]
    v_pk_fma_f32 v[64:65], v[66:67], v[52:53], v[64:65] op_sel:[1,1,0] op_sel_hi:[0,1,1] neg_lo:[1,0,0]
    v_cvt_pk_bf16_f32 v84, v64, v65
    ds_write_addtid_b32 v84 offset:49536
    v_pk_mul_f32 v[66:67], v[64:65], v[52:53] op_sel:[0,0] op_sel_hi:[1,0]
    v_pk_fma_f32 v[66:67], v[64:65], v[52:53], v[66:67] op_sel:[1,1,0] op_sel_hi:[0,1,1] neg_lo:[1,0,0]
    v_cvt_pk_bf16_f32 v85, v66, v67
    ds_write_addtid_b32 v85 offset:51600
    v_pk_mul_f32 v[64:65], v[66:67], v[52:53] op_sel:[0,0] op_sel_hi:[1,0]
    v_pk_fma_f32 v[64:65], v[66:67], v[52:53], v[64:65] op_sel:[1,1,0] op_sel_hi:[0,1,1] neg_lo:[1,0,0]
    v_cvt_pk_bf16_f32 v84, v64, v65
    ds_write_addtid_b32 v84 offset:53664
    v_pk_mul_f32 v[66:67], v[64:65], v[52:53] op_sel:[0,0] op_sel_hi:[1,0]
    v_pk_fma_f32 v[66:67], v[64:65], v[52:53], v[66:67] op_sel:[1,1,0] op_sel_hi:[0,1,1] neg_lo:[1,0,0]
    v_cvt_pk_bf16_f32 v85, v66, v67
    ds_write_addtid_b32 v85 offset:55728
    v_pk_mul_f32 v[64:65], v[66:67], v[52:53] op_sel:[0,0] op_sel_hi:[1,0]
    v_pk_fma_f32 v[64:65], v[66:67], v[52:53], v[64:65] op_sel:[1,1,0] op_sel_hi:[0,1,1] neg_lo:[1,0,0]
    v_cvt_pk_bf16_f32 v84, v64, v65
    ds_write_addtid_b32 v84 offset:57792
    s_cmp_eq_u32 s63, 0
    s_cbranch_scc1 L_gc_7
    s_mov_b32 s63, 0
    global_load_dwordx2 v[96:97], v94, s[16:17] offset:0
    global_load_dwordx2 v[98:99], v94, s[16:17] offset:1280
    global_load_dwordx2 v[100:101], v94, s[16:17] offset:2560
    global_load_dwordx2 v[102:103], v94, s[16:17] offset:3840
L_gc_7:
    v_pk_mul_f32 v[66:67], v[64:65], v[52:53] op_sel:[0,0] op_sel_hi:[1,0]
    v_pk_fma_f32 v[66:67], v[64:65], v[52:53], v[66:67] op_sel:[1,1,0] op_sel_hi:[0,1,1] neg_lo:[1,0,0]
    v_cvt_pk_bf16_f32 v85, v66, v67
    ds_write_addtid_b32 v85 offset:59856
    v_pk_mul_f32 v[64:65], v[66:67], v[52:53] op_sel:[0,0] op_sel_hi:[1,0]
    v_pk_fma_f32 v[64:65], v[66:67], v[52:53], v[64:65] op_sel:[1,1,0] op_sel_hi:[0,1,1] neg_lo:[1,0,0]
    v_cvt_pk_bf16_f32 v84, v64, v65
    ds_write_addtid_b32 v84 offset:61920
    v_pk_mul_f32 v[66:67], v[64:65], v[52:53] op_sel:[0,0] op_sel_hi:[1,0]
    v_pk_fma_f32 v[66:67], v[64:65], v[52:53], v[66:67] op_sel:[1,1,0] op_sel_hi:[0,1,1] neg_lo:[1,0,0]
    v_cvt_pk_bf16_f32 v85, v66, v67
    ds_write_addtid_b32 v85 offset:63984
    s_mov_b32 m0, s50
    v_pk_mul_f32 v[56:57], v[50:51], v[50:51] op_sel:[0,0] op_sel_hi:[1,0]
    v_pk_fma_f32 v[56:57], v[50:51], v[50:51], v[56:57] op_sel:[1,1,0] op_sel_hi:[0,1,1] neg_lo:[1,0,0]
    v_cvt_pk_bf16_f32 v84, v48, v49
    ds_write_addtid_b32 v84 offset:0
    v_pk_mul_f32 v[66:67], v[48:49], v[50:51] op_sel:[0,0] op_sel_hi:[1,0]
    v_pk_fma_f32 v[66:67], v[48:49], v[50:51], v[66:67] op_sel:[1,1,0] op_sel_hi:[0,1,1] neg_lo:[1,0,0]
    v_cvt_pk_bf16_f32 v85, v66, v67
    ds_write_addtid_b32 v85 offset:2064
    v_pk_mul_f32 v[64:65], v[66:67], v[50:51] op_sel:[0,0] op_sel_hi:[1,0]
    v_pk_fma_f32 v[64:65], v[66:67], v[50:51], v[64:65] op_sel:[1,1,0] op_sel_hi:[0,1,1] neg_lo:[1,0,0]
    v_cvt_pk_bf16_f32 v84, v64, v65
    ds_write_addtid_b32 v84 offset:4128
    v_pk_mul_f32 v[66:67], v[64:65], v[50:51] op_sel:[0,0] op_sel_hi:[1,0]
    v_pk_fma_f32 v[66:67], v[64:65], v[50:51], v[66:67] op_sel:[1,1,0] op_sel_hi:[0,1,1] neg_lo:[1,0,0]
    v_cvt_pk_bf16_f32 v85, v66, v67
    ds_write_addtid_b32 v85 offset:6192
    v_pk_mul_f32 v[64:65], v[66:67], v[50:51] op_sel:[0,0] op_sel_hi:[1,0]
    v_pk_fma_f32 v[64:65], v[66:67], v[50:51], v[64:65] op_sel:[1,1,0] op_sel_hi:[0,1,1] neg_lo:[1,0,0]
    v_cvt_pk_bf16_f32 v84, v64, v65
    ds_write_addtid_b32 v84 offset:8256
    ds_write_addtid_b32 v84 offset:16512
    v_pk_mul_f32 v[66:67], v[64:65], v[50:51] op_sel:[0,0] op_sel_hi:[1,0]
    v_pk_fma_f32 v[66:67], v[64:65], v[50:51], v[66:67] op_sel:[1,1,0] op_sel_hi:[0,1,1] neg_lo:[1,0,0]
    v_cvt_pk_bf16_f32 v85, v66, v67
    ds_write_addtid_b32 v85 offset:10320
    v_pk_mul_f32 v[64:65], v[66:67], v[50:51] op_sel:[0,0] op_sel_hi:[1,0]
    v_pk_fma_f32 v[64:65], v[66:67], v[50:51], v[64:65] op_sel:[1,1,0] op_sel_hi:[0,1,1] neg_lo:[1,0,0]
    v_cvt_pk_bf16_f32 v84, v64, v65
    ds_write_addtid_b32 v84 offset:12384
    v_pk_mul_f32 v[66:67], v[64:65], v[50:51] op_sel:[0,0] op_sel_hi:[1,0]
    v_pk_fma_f32 v[66:67], v[64:65], v[50:51], v[66:67] op_sel:[1,1,0] op_sel_hi:[0,1,1] neg_lo:[1,0,0]
    v_cvt_pk_bf16_f32 v85, v66, v67
    ds_write_addtid_b32 v85 offset:14448
    v_pk_mul_f32 v[64:65], v[66:67], v[50:51] op_sel:[0,0] op_sel_hi:[1,0]
    v_pk_fma_f32 v[64:65], v[66:67], v[50:51], v[64:65] op_sel:[1,1,0] op_sel_hi:[0,1,1] neg_lo:[1,0,0]
    v_cvt_pk_bf16_f32 v84, v64, v65
    ds_write_addtid_b32 v84 offset:24768
    v_pk_mul_f32 v[68:69], v[48:49], v[54:55] op_sel:[0,0] op_sel_hi:[1,0]
    v_pk_fma_f32 v[68:69], v[48:49], v[54:55], v[68:69] op_sel:[1,1,0] op_sel_hi:[0,1,1] neg_lo:[1,0,0]
    v_cvt_pk_bf16_f32 v85, v68, v69
    ds_write_addtid_b32 v85 offset:18576
    v_pk_mul_f32 v[70:71], v[68:69], v[56:57] op_sel:[0,0] op_sel_hi:[1,0]
    v_pk_fma_f32 v[70:71], v[68:69], v[56:57], v[70:71] op_sel:[1,1,0] op_sel_hi:[0,1,1] neg_lo:[1,0,0]
    v_cvt_pk_bf16_f32 v84, v70, v71
    ds_write_addtid_b32 v84 offset:20640
    v_pk_mul_f32 v[68:69], v[70:71], v[56:57] op_sel:[0,0] op_sel_hi:[1,0]
    v_pk_fma_f32 v[68:69], v[70:71], v[56:57], v[68:69] op_sel:[1,1,0] op_sel_hi:[0,1,1] neg_lo:[1,0,0]
    v_cvt_pk_bf16_f32 v85, v68, v69
    ds_write_addtid_b32 v85 offset:22704
    ds_write_addtid_b32 v85 offset:26832
    v_pk_mul_f32 v[70:71], v[68:69], v[56:57] op_sel:[0,0] op_sel_hi:[1,0]
    v_pk_fma_f32 v[70:71], v[68:69], v[56:57], v[70:71] op_sel:[1,1,0] op_sel_hi:[0,1,1] neg_lo:[1,0,0]
    v_cvt_pk_bf16_f32 v84, v70, v71
    ds_write_addtid_b32 v84 offset:28896
    v_pk_mul_f32 v[72:73], v[70:71], v[56:57] op_sel:[0,0] op_sel_hi:[1,0]
    v_pk_fma_f32 v[72:73], v[70:71], v[56:57], v[72:73] op_sel:[1,1,0] op_sel_hi:[0,1,1] neg_lo:[1,0,0]
    v_cvt_pk_bf16_f32 v85, v72, v73
    ds_write_addtid_b32 v85 offset:30960
    v_pk_mul_f32 v[70:71], v[68:69], v[54:55] op_sel:[0,0] op_sel_hi:[1,0]
    v_pk_fma_f32 v[70:71], v[68:69], v[54:55], v[70:71] op_sel:[1,1,0] op_sel_hi:[0,1,1] neg_lo:[1,0,0]
    v_cvt_pk_bf16_f32 v84, v70, v71
    ds_write_addtid_b32 v84 offset:33024
    v_pk_mul_f32 v[74:75], v[72:73], v[54:55] op_sel:[0,0] op_sel_hi:[1,0]
    v_pk_fma_f32 v[74:75], v[72:73], v[54:55], v[74:75] op_sel:[1,1,0] op_sel_hi:[0,1,1] neg_lo:[1,0,0]
    v_cvt_pk_bf16_f32 v85, v74, v75
    ds_write_addtid_b32 v85 offset:35088
    v_pk_mul_f32 v[68:69], v[70:71], v[54:55] op_sel:[0,0] op_sel_hi:[1,0]
    v_pk_fma_f32 v[68:69], v[70:71], v[54:55], v[68:69] op_sel:[1,1,0] op_sel_hi:[0,1,1] neg_lo:[1,0,0]
    v_cvt_pk_bf16_f32 v84, v68, v69
    ds_write_addtid_b32 v84 offset:41280
    v_pk_mul_f32 v[72:73], v[74:75], v[54:55] op_sel:[0,0] op_sel_hi:[1,0]
    v_pk_fma_f32 v[72:73], v[74:75], v[54:55], v[72:73] op_sel:[1,1,0] op_sel_hi:[0,1,1] neg_lo:[1,0,0]
    v_cvt_pk_bf16_f32 v85, v72, v73
    ds_write_addtid_b32 v85 offset:43344
    v_pk_mul_f32 v[74:75], v[72:73], v[54:55] op_sel:[0,0] op_sel_hi:[1,0]
    v_pk_fma_f32 v[74:75], v[72:73], v[54:55], v[74:75] op_sel:[1,1,0] op_sel_hi:[0,1,1] neg_lo:[1,0,0]
    v_cvt_pk_bf16_f32 v84, v74, v75
    ds_write_addtid_b32 v84 offset:37152
    v_pk_mul_f32 v[72:73], v[74:75], v[54:55] op_sel:[0,0] op_sel_hi:[1,0]
    v_pk_fma_f32 v[72:73], v[74:75], v[54:55], v[72:73] op_sel:[1,1,0] op_sel_hi:[0,1,1] neg_lo:[1,0,0]
    v_cvt_pk_bf16_f32 v85, v72, v73
    ds_write_addtid_b32 v85 offset:39216
    v_pk_mul_f32 v[74:75], v[72:73], v[54:55] op_sel:[0,0] op_sel_hi:[1,0]
    v_pk_fma_f32 v[74:75], v[72:73], v[54:55], v[74:75] op_sel:[1,1,0] op_sel_hi:[0,1,1] neg_lo:[1,0,0]
    v_cvt_pk_bf16_f32 v84, v74, v75
    ds_write_addtid_b32 v84 offset:45408
    v_pk_mul_f32 v[72:73], v[74:75], v[54:55] op_sel:[0,0] op_sel_hi:[1,0]
    v_pk_fma_f32 v[72:73], v[74:75], v[54:55], v[72:73] op_sel:[1,1,0] op_sel_hi:[0,1,1] neg_lo:[1,0,0]
    v_cvt_pk_bf16_f32 v85, v72, v73
    ds_write_addtid_b32 v85 offset:47472
    s_cmp_ge_u32 s3, 4
    s_cbranch_scc1 L_nx_8
    s_mov_b32 exec_hi, 0
    global_load_dword v251, v93, s[16:17]
    s_mov_b64 exec, -1
L_nx_8:
    s_cmp_ge_u32 s3, 4
    s_cbranch_scc1 L_helper
    v_and_b32 v2, 31, v1
    v_lshrrev_b32 v3, 5, v1
    v_mul_u32_u24 v5, 2064, v2
    v_subrev_u32 v6, 33024, v5
    v_cmp_le_u32 vcc, 24, v2
    s_lshl_b32 s5, s45, 9
    v_lshl_add_u32 v7, v3, 4, s5
    v_cndmask_b32 v6, v5, v6, vcc
    v_add_u32 v5, v5, v7
    v_add_u32 v6, v6, v7
    v_add_u32 v5, 49536, v5
    s_waitcnt lgkmcnt(0)
    s_mul_i32 s52, s45, 6432
    s_add_u32 s52, s52, 135040
    v_mul_u32_u24 v208, 80, v2
    v_lshl_add_u32 v208, v3, 5, v208
    v_add_u32 v208, s52, v208
    v_add_u32 v207, 2560, v208
    v_lshl_add_u32 v206, v3, 4, v208
    v_add_u32 v205, 2560, v206
    v_lshlrev_b32 v209, 2, v2
    v_lshl_add_u32 v209, v3, 7, v209
    v_add_u32 v209, s52, v209
    v_lshlrev_b32 v210, 1, v2
    v_lshl_add_u32 v210, v3, 7, v210
    v_add_u32 v210, s52, v210
    v_mov_b32 v211, s52
    v_lshlrev_b32 v45, 16, v46
    v_cmp_eq_u32 vcc, 0, v1
    v_and_b32 v232, 15, v1
    v_lshrrev_b32 v233, 4, v1
    v_cndmask_b32 v45, 0, v45, vcc
    v_lshlrev_b32 v234, 3, v233
    v_sub_u32 v234, v232, v234
    v_add_u32 v240, 25, v234
    v_add_u32 v234, 29, v234
    v_lshrrev_b32 v241, 3, v234
    v_lshl_add_u32 v234, v234, 3, s52
    v_lshl_add_u32 v234, v241, 4, v234
    v_lshrrev_b32 v241, 3, v240
    v_lshl_add_u32 v240, v240, 3, s52
    v_lshl_add_u32 v240, v241, 4, v240
    v_lshlrev_b32 v235, 2, v233
    v_sub_u32 v235, v232, v235
    v_add_u32 v235, 12, v235
    v_lshl_add_u32 v236, v235, 2, s52
    v_lshl_add_u32 v235, v235, 3, s52
    v_add_u32 v236, 6112, v236
    v_lshlrev_b32 v244, 5, v232
    v_lshl_add_u32 v244, v233, 4, v244
    v_add_u32 v244, s53, v244
    v_lshrrev_b32 v248, 1, v232
    v_add_u32 v248, v248, v233
    v_and_b32 v248, 3, v248
    v_and_b32 v249, 7, v232
    v_lshlrev_b32 v249, 6, v249
    v_lshl_add_u32 v249, v248, 4, v249
    v_lshrrev_b32 v248, 3, v232
    v_mul_u32_u24 v248, 2064, v248
    v_add3_u32 v245, v248, v249, s5
    s_lshl_b32 s5, s45, 2
    v_add_u32 v249, s5, v246
    s_mul_i32 s5, s44, 7168
    s_lshl_b32 s6, s45, 5
    s_add_u32 s5, s5, s6
    s_add_u32 s5, s5, 65536
    v_lshlrev_b32 v2, 7, v2
    v_lshl_add_u32 v2, v3, 4, v2
    v_add_u32 v2, s5, v2
    v_add_u32 v3, 4096, v2
    s_and_b32 s18, s4, 0xff
    s_bfe_u32 s19, s4, 0x80008
    s_bfe_u32 s20, s4, 0x80010
    s_lshr_b32 s21, s4, 24
    s_mov_b32 s56, 0x3fffff
    s_mov_b32 s57, 0x3fffff
    s_barrier
    ds_read_b128 v[156:159], v6 offset:0
    ds_read_b128 v[160:163], v5 offset:0
    ds_read_b128 v[164:167], v6 offset:32
    ds_read_b128 v[168:171], v5 offset:32
    ds_read_b128 v[172:175], v6 offset:64
    ds_read_b128 v[176:179], v5 offset:64
    ds_read_b128 v[180:183], v6 offset:96
    ds_read_b128 v[184:187], v5 offset:96
    ds_read_b128 v[188:191], v6 offset:128
    ds_read_b128 v[192:195], v5 offset:128
    ds_read_b128 v[196:199], v6 offset:160
    ds_read_b128 v[200:203], v5 offset:160
    s_waitcnt lgkmcnt(10)
    v_mfma_f32_32x32x16_bf16 v[140:155], v[156:159], v[160:163], 0
    ds_read_b128 v[156:159], v6 offset:192
    ds_read_b128 v[160:163], v5 offset:192
    s_waitcnt lgkmcnt(10)
    v_mfma_f32_32x32x16_bf16 v[140:155], v[164:167], v[168:171], v[140:155]
    ds_read_b128 v[164:167], v6 offset:224
    ds_read_b128 v[168:171], v5 offset:224
    s_waitcnt lgkmcnt(10)
    v_mfma_f32_32x32x16_bf16 v[140:155], v[172:175], v[176:179], v[140:155]
    ds_read_b128 v[172:175], v6 offset:256
    ds_read_b128 v[176:179], v5 offset:256
    s_waitcnt lgkmcnt(10)
    v_mfma_f32_32x32x16_bf16 v[140:155], v[180:183], v[184:187], v[140:155]
    ds_read_b128 v[180:183], v6 offset:288
    ds_read_b128 v[184:187], v5 offset:288
    s_waitcnt lgkmcnt(10)
    v_mfma_f32_32x32x16_bf16 v[140:155], v[188:191], v[192:195], v[140:155]
    ds_read_b128 v[188:191], v6 offset:320
    ds_read_b128 v[192:195], v5 offset:320
    s_waitcnt lgkmcnt(10)
    v_mfma_f32_32x32x16_bf16 v[140:155], v[196:199], v[200:203], v[140:155]
    ds_read_b128 v[196:199], v6 offset:352
    ds_read_b128 v[200:203], v5 offset:352
    s_waitcnt lgkmcnt(10)
    v_mfma_f32_32x32x16_bf16 v[140:155], v[156:159], v[160:163], v[140:155]
    ds_read_b128 v[156:159], v6 offset:384
    ds_read_b128 v[160:163], v5 offset:384
    s_waitcnt lgkmcnt(10)
    v_mfma_f32_32x32x16_bf16 v[140:155], v[164:167], v[168:171], v[140:155]
    ds_read_b128 v[164:167], v6 offset:416
    ds_read_b128 v[168:171], v5 offset:416
    s_waitcnt lgkmcnt(10)
    v_mfma_f32_32x32x16_bf16 v[140:155], v[172:175], v[176:179], v[140:155]
    ds_read_b128 v[172:175], v6 offset:448
    ds_read_b128 v[176:179], v5 offset:448
    s_waitcnt lgkmcnt(10)
    v_mfma_f32_32x32x16_bf16 v[140:155], v[180:183], v[184:187], v[140:155]
    ds_read_b128 v[180:183], v6 offset:480
    ds_read_b128 v[184:187], v5 offset:480
    s_waitcnt lgkmcnt(10)
    v_mfma_f32_32x32x16_bf16 v[140:155], v[188:191], v[192:195], v[140:155]
    ds_read2_b32 v[120:121], v92 offset0:19 offset1:17
    ds_read2_b32 v[122:123], v92 offset0:15 offset1:13
    ds_read2_b32 v[76:77], v92 offset0:20 offset1:18
    s_waitcnt lgkmcnt(11)
    v_mfma_f32_32x32x16_bf16 v[140:155], v[196:199], v[200:203], v[140:155]
    ds_read2_b32 v[78:79], v92 offset0:16 offset1:14
    ds_read2_b32 v[224:225], v92 offset0:22 offset1:20
    ds_read2_b32 v[226:227], v92 offset0:18 offset1:16
    s_waitcnt lgkmcnt(12)
    v_mfma_f32_32x32x16_bf16 v[140:155], v[156:159], v[160:163], v[140:155]
    ds_read2_b32 v[124:125], v92 offset0:79 offset1:77
    ds_read2_b32 v[126:127], v92 offset0:75 offset1:73
    ds_read2_b32 v[128:129], v92 offset0:11 offset1:9
    s_waitcnt lgkmcnt(13)
    v_mfma_f32_32x32x16_bf16 v[140:155], v[164:167], v[168:171], v[140:155]
    ds_read2_b32 v[130:131], v92 offset0:7 offset1:5
    ds_read2_b32 v[132:133], v92 offset0:143 offset1:141
    ds_read2_b32 v[134:135], v92 offset0:139 offset1:137
    s_waitcnt lgkmcnt(14)
    v_mfma_f32_32x32x16_bf16 v[140:155], v[172:175], v[176:179], v[140:155]
    ds_read2_b32 v[136:137], v92 offset0:207 offset1:205
    ds_read2_b32 v[138:139], v92 offset0:203 offset1:201
    s_waitcnt lgkmcnt(14)
    v_mfma_f32_32x32x16_bf16 v[140:155], v[180:183], v[184:187], v[140:155]
    ds_read_b32 v250, v246
    s_nop 10
    v_add_f32 v140, v140, v45
    v_cvt_pk_bf16_f32 v215, v142, v141
    v_cvt_pk_bf16_f32 v212, v143, v142
    v_cvt_pk_bf16_f32 v214, v144, v143
    v_cvt_pk_bf16_f32 v213, v141, v140
    v_cvt_pk_bf16_f32 v222, v140, 0
    v_cvt_pk_bf16_f32 v217, v145, v145
    v_cvt_pk_bf16_f32 v219, v146, v145
    v_cvt_pk_bf16_f32 v216, v147, v146
    v_cvt_pk_bf16_f32 v218, v147, v147
    v_cvt_pk_bf16_f32 v220, v148, v149
    v_cvt_pk_bf16_f32 v221, v150, v151
    v_cvt_pk_bf16_f32 v223, v149, v149
    s_waitcnt lgkmcnt(0)
    v_readfirstlane_b32 s5, v250
    ds_write_b128 v208, v[212:215] offset:160
    ds_write2_b32 v206, v213, v215 offset0:32 offset1:34
    ds_write2_b32 v208, v212, v214 offset0:45 offset1:47
    ds_write_b128 v207, v[216:219] offset:160
    ds_write2_b32 v205, v217, v219 offset0:32 offset1:34
    ds_write2_b32 v207, v216, v218 offset0:45 offset1:47
    s_mov_b64 exec, 1
    ds_write2_b32 v211, v222, v222 offset0:30 offset1:35
    s_mov_b64 exec, -1
    ds_read_b64 v[8:9], v234 offset:0
    ds_read_b64 v[10:11], v240 offset:0
    ds_read_b64 v[40:41], v234 offset:2560
    ds_read_b64 v[42:43], v240 offset:2560
    s_cmp_lg_u32 s5, 0
    s_cbranch_scc1 L_fast01
    ds_read_b64 v[12:13], v234 offset:320
    ds_read_b64 v[14:15], v240 offset:320
    ds_read_b64 v[44:45], v234 offset:2880
    ds_read_b64 v[46:47], v240 offset:2880
    ds_read_b64 v[16:17], v234 offset:640
    ds_read_b64 v[18:19], v240 offset:640
    ds_read_b64 v[48:49], v234 offset:3200
    ds_read_b64 v[50:51], v240 offset:3200
    ds_read_b64 v[20:21], v234 offset:960
    ds_read_b64 v[22:23], v240 offset:960
    ds_read_b64 v[52:53], v234 offset:3520
    ds_read_b64 v[54:55], v240 offset:3520
    ds_read_b64 v[24:25], v234 offset:1280
    ds_read_b64 v[26:27], v240 offset:1280
    ds_read_b64 v[56:57], v234 offset:3840
    ds_read_b64 v[58:59], v240 offset:3840
    ds_read_b64 v[28:29], v234 offset:1600
    ds_read_b64 v[30:31], v240 offset:1600
    ds_read_b64 v[60:61], v234 offset:4160
    ds_read_b64 v[62:63], v240 offset:4160
    ds_read_b64 v[32:33], v234 offset:1920
    ds_read_b64 v[34:35], v240 offset:1920
    ds_read_b64 v[64:65], v234 offset:4480
    ds_read_b64 v[66:67], v240 offset:4480
    ds_read_b64 v[36:37], v234 offset:2240
    ds_read_b64 v[38:39], v240 offset:2240
    ds_read_b64 v[68:69], v234 offset:4800
    ds_read_b64 v[70:71], v240 offset:4800
    ds_write_b32 v209, v220 offset:5728
    ds_write_b16 v210, v221 offset:6176
    ds_write_b16_d16_hi v210, v221 offset:6240
    ds_read_b64 v[72:73], v234 offset:5120
    ds_read_b64 v[74:75], v240 offset:5120
    ds_read_b64 v[80:81], v235 offset:5632
    ds_read_b64 v[82:83], v235 offset:5624
    ds_read_b64 v[84:85], v235 offset:5616
    ds_read_b64 v[86:87], v235 offset:5608
    ds_read_b64 v[88:89], v235 offset:5760
    ds_read_b64 v[90:91], v235 offset:5752
    ds_read_b64 v[92:93], v235 offset:5744
    ds_read_b64 v[94:95], v235 offset:5736
    ds_read_b64 v[96:97], v235 offset:5888
    ds_read_b64 v[98:99], v235 offset:5880
    ds_read_b64 v[100:101], v235 offset:5872
    ds_read_b64 v[102:103], v235 offset:5864
    ds_read2_b32 v[104:105], v236 offset0:4 offset1:3
    ds_read2_b32 v[106:107], v236 offset0:2 offset1:1
    ds_read2_b32 v[108:109], v236 offset0:20 offset1:19
    ds_read2_b32 v[110:111], v236 offset0:18 offset1:17
    ds_read2_b32 v[112:113], v236 offset0:36 offset1:35
    ds_read2_b32 v[114:115], v236 offset0:34 offset1:33
    ds_read2_b32 v[116:117], v236 offset0:52 offset1:51
    ds_read2_b32 v[118:119], v236 offset0:50 offset1:49
    s_mov_b32 s54, 1048576
L_u0_9:
    ds_read_b32 v250, v246 offset:0
    s_waitcnt lgkmcnt(0)
    v_readfirstlane_b32 s5, v250
    s_sub_u32 s54, s54, 1
    s_cbranch_scc1 L_u0o_10
    s_cmp_lt_u32 s5, 1
    s_cbranch_scc1 L_u0_9
L_u0o_10:
    ds_read_b128 v[172:175], v244 offset:480
    ds_read_b128 v[176:179], v244 offset:416
    ds_read_b128 v[180:183], v244 offset:352
    ds_read_b128 v[184:187], v244 offset:288
    ds_read_b128 v[188:191], v244 offset:224
    s_waitcnt lgkmcnt(4)
    v_mfma_f32_16x16x32_bf16 v[140:143], v[8:11], v[172:175], 0
    ds_read_b32 v250, v246 offset:4
    ds_read_b128 v[192:195], v244 offset:160
    v_and_b32 v76, v76, v120
    v_and_b32 v77, v77, v121
    v_mfma_f32_16x16x32_bf16 v[144:147], v[40:43], v[172:175], 0
    v_and_b32 v78, v78, v122
    s_waitcnt lgkmcnt(5)
    v_mfma_f32_16x16x32_bf16 v[140:143], v[12:15], v[176:179], v[140:143]
    ds_read_b128 v[172:175], v244 offset:96
    v_and_b32 v79, v79, v123
    v_mfma_f32_16x16x32_bf16 v[144:147], v[44:47], v[176:179], v[144:147]
    v_pk_lshlrev_b16 v76, 2, v76 op_sel_hi:[0,1]
    s_waitcnt lgkmcnt(5)
    v_mfma_f32_16x16x32_bf16 v[140:143], v[16:19], v[180:183], v[140:143]
    ds_read_b128 v[176:179], v244 offset:32
    v_pk_ashrrev_i16 v76, 15, v76 op_sel_hi:[0,1]
    v_pk_lshlrev_b16 v77, 2, v77 op_sel_hi:[0,1]
    v_mfma_f32_16x16x32_bf16 v[144:147], v[48:51], v[180:183], v[144:147]
    v_pk_ashrrev_i16 v77, 15, v77 op_sel_hi:[0,1]
    s_waitcnt lgkmcnt(5)
    s_waitcnt lgkmcnt(3)
    v_readfirstlane_b32 s5, v250
    v_mfma_f32_16x16x32_bf16 v[140:143], v[20:23], v[184:187], v[140:143]
    s_cmp_eq_u32 s5, 0
    s_cbranch_scc1 L_uslow1a
L_uok1a:
    ds_read_b128 v[180:183], v244 offset:992
    v_pk_lshlrev_b16 v78, 2, v78 op_sel_hi:[0,1]
    v_mfma_f32_16x16x32_bf16 v[144:147], v[52:55], v[184:187], v[144:147]
    v_pk_ashrrev_i16 v78, 15, v78 op_sel_hi:[0,1]
    v_mfma_f32_16x16x32_bf16 v[140:143], v[24:27], v[188:191], v[140:143]
    ds_read_b128 v[184:187], v244 offset:928
    v_pk_lshlrev_b16 v79, 2, v79 op_sel_hi:[0,1]
    v_pk_ashrrev_i16 v79, 15, v79 op_sel_hi:[0,1]
    v_mfma_f32_16x16x32_bf16 v[144:147], v[56:59], v[188:191], v[144:147]
    v_pk_lshlrev_b16 v224, 2, v224 op_sel_hi:[0,1]
    s_waitcnt lgkmcnt(4)
    v_mfma_f32_16x16x32_bf16 v[140:143], v[28:31], v[192:195], v[140:143]
    ds_read_b128 v[188:191], v244 offset:864
    v_pk_ashrrev_i16 v224, 15, v224 op_sel_hi:[0,1]
    v_mfma_f32_16x16x32_bf16 v[144:147], v[60:63], v[192:195], v[144:147]
    v_pk_lshlrev_b16 v225, 2, v225 op_sel_hi:[0,1]
    s_waitcnt lgkmcnt(4)
    v_mfma_f32_16x16x32_bf16 v[140:143], v[32:35], v[172:175], v[140:143]
    ds_read_b128 v[192:195], v244 offset:800
    v_pk_ashrrev_i16 v225, 15, v225 op_sel_hi:[0,1]
    v_pk_lshlrev_b16 v226, 2, v226 op_sel_hi:[0,1]
    v_mfma_f32_16x16x32_bf16 v[144:147], v[64:67], v[172:175], v[144:147]
    v_pk_ashrrev_i16 v226, 15, v226 op_sel_hi:[0,1]
    s_waitcnt lgkmcnt(4)
    v_mfma_f32_16x16x32_bf16 v[140:143], v[36:39], v[176:179], v[140:143]
    ds_read_b128 v[172:175], v244 offset:736
    v_pk_lshlrev_b16 v227, 2, v227 op_sel_hi:[0,1]
    v_mfma_f32_16x16x32_bf16 v[144:147], v[68:71], v[176:179], v[144:147]
    v_pk_ashrrev_i16 v227, 15, v227 op_sel_hi:[0,1]
    s_waitcnt lgkmcnt(4)
    v_mfma_f32_16x16x32_bf16 v[144:147], v[8:11], v[180:183], v[144:147]
    ds_read_b32 v250, v246 offset:8
    ds_read_b128 v[176:179], v244 offset:672
    v_mfma_f32_16x16x32_bf16 v[148:151], v[40:43], v[180:183], 0
    s_waitcnt lgkmcnt(5)
    v_mfma_f32_16x16x32_bf16 v[144:147], v[12:15], v[184:187], v[144:147]
    ds_read_b128 v[180:183], v244 offset:608
    v_readlane_b32 s6, v218, 63
    v_mfma_f32_16x16x32_bf16 v[148:151], v[44:47], v[184:187], v[148:151]
    v_readlane_b32 s7, v223, 63
    s_waitcnt lgkmcnt(5)
    v_mfma_f32_16x16x32_bf16 v[144:147], v[16:19], v[188:191], v[144:147]
    ds_read_b128 v[184:187], v244 offset:544
    ds_write_b128 v245, v[140:143] offset:0
    v_mfma_f32_16x16x32_bf16 v[148:151], v[48:51], v[188:191], v[148:151]
    ds_write_b32 v249, v247 offset:48
    v_and_b32 v76, s7, v76
    s_waitcnt lgkmcnt(7)
    s_waitcnt lgkmcnt(5)
    v_readfirstlane_b32 s5, v250
    v_mfma_f32_16x16x32_bf16 v[144:147], v[20:23], v[192:195], v[144:147]
    s_cmp_eq_u32 s5, 0
    s_cbranch_scc1 L_uslow2a
L_uok2a:
    ds_read_b128 v[188:191], v244 offset:1504
    v_and_b32 v77, s7, v77
    v_mfma_f32_16x16x32_bf16 v[148:151], v[52:55], v[192:195], v[148:151]
    v_and_b32 v78, s7, v78
    v_mfma_f32_16x16x32_bf16 v[144:147], v[24:27], v[172:175], v[144:147]
    ds_read_b128 v[196:199], v244 offset:480
    v_and_b32 v79, s7, v79
    v_mfma_f32_16x16x32_bf16 v[148:151], v[56:59], v[172:175], v[148:151]
    s_waitcnt lgkmcnt(6)
    v_mfma_f32_16x16x32_bf16 v[144:147], v[28:31], v[176:179], v[144:147]
    ds_read_b128 v[200:203], v244 offset:464
    v_and_or_b32 v72, v224, s6, v72
    v_mfma_f32_16x16x32_bf16 v[148:151], v[60:63], v[176:179], v[148:151]
    v_and_or_b32 v73, v225, s6, v73
    s_waitcnt lgkmcnt(6)
    v_mfma_f32_16x16x32_bf16 v[144:147], v[32:35], v[180:183], v[144:147]
    ds_read_b128 v[192:195], v244 offset:1440
    v_and_or_b32 v74, v226, s6, v74
    v_mfma_f32_16x16x32_bf16 v[148:151], v[64:67], v[180:183], v[148:151]
    v_and_or_b32 v75, v227, s6, v75
    s_waitcnt lgkmcnt(6)
    v_mfma_f32_16x16x32_bf16 v[144:147], v[36:39], v[184:187], v[144:147]
    ds_read_b128 v[172:175], v244 offset:1376
    v_mfma_f32_16x16x32_bf16 v[148:151], v[68:71], v[184:187], v[148:151]
L_join:
    s_waitcnt lgkmcnt(4)
    v_mfma_f32_16x16x32_bf16 v[148:151], v[8:11], v[188:191], v[148:151]
    ds_read_b128 v[176:179], v244 offset:1312
    v_mfma_f32_16x16x32_bf16 v[152:155], v[40:43], v[188:191], 0
    s_waitcnt lgkmcnt(4)
    v_mfma_f32_16x16x32_bf16 v[208:211], v[196:199], v[120:123], 0
    ds_read_b128 v[180:183], v244 offset:1248
    v_mfma_f32_16x16x32_bf16 v[212:215], v[196:199], v[124:127], 0
    v_mfma_f32_16x16x32_bf16 v[216:219], v[196:199], v[128:131], 0
    ds_write_b128 v245, v[144:147] offset:4128
    v_mfma_f32_16x16x32_bf16 v[228:231], v[196:199], v[132:135], 0
    ds_write_b32 v249, v247 offset:64
    v_mfma_f32_16x16x32_bf16 v[148:151], v[72:75], v[196:199], v[148:151]
    s_waitcnt lgkmcnt(6)
    v_mfma_f32_16x16x32_bf16 v[220:223], v[200:203], v[124:127], 0
    ds_read_b128 v[184:187], v244 offset:1184
    s_waitcnt vmcnt(0)
    v_mfma_f32_16x16x32_bf16 v[4:7], v[200:203], v[136:139], 0
    ds_read_b32 v250, v246 offset:12
    v_mfma_f32_16x16x32_bf16 v[140:143], v[76:79], v[196:199], 0
    s_waitcnt lgkmcnt(7)
    v_mfma_f32_16x16x32_bf16 v[148:151], v[12:15], v[192:195], v[148:151]
    ds_read_b128 v[188:191], v244 offset:1120
    v_mfma_f32_16x16x32_bf16 v[152:155], v[44:47], v[192:195], v[152:155]
    s_waitcnt lgkmcnt(7)
    v_mfma_f32_16x16x32_bf16 v[148:151], v[16:19], v[172:175], v[148:151]
    ds_read_b128 v[192:195], v244 offset:1056
    v_cvt_pk_bf16_f32 v156, v208, v212
    v_mfma_f32_16x16x32_bf16 v[152:155], v[48:51], v[172:175], v[152:155]
    v_cvt_pk_bf16_f32 v158, v209, v213
    s_waitcnt lgkmcnt(7)
    s_waitcnt lgkmcnt(2)
    v_readfirstlane_b32 s5, v250
    v_mfma_f32_16x16x32_bf16 v[148:151], v[20:23], v[176:179], v[148:151]
    s_cmp_eq_u32 s5, 0
    s_cbranch_scc1 L_uslow3
L_uok3:
    ds_read_b128 v[172:175], v244 offset:2016
    v_cvt_pk_bf16_f32 v160, v210, v214
    v_mfma_f32_16x16x32_bf16 v[152:155], v[52:55], v[176:179], v[152:155]
    v_cvt_pk_bf16_f32 v162, v211, v215
    v_mfma_f32_16x16x32_bf16 v[148:151], v[24:27], v[180:183], v[148:151]
    ds_read_b128 v[196:199], v244 offset:992
    v_cvt_pk_bf16_f32 v157, v216, v220
    v_mfma_f32_16x16x32_bf16 v[152:155], v[56:59], v[180:183], v[152:155]
    v_cvt_pk_bf16_f32 v159, v217, v221
    v_mfma_f32_16x16x32_bf16 v[148:151], v[28:31], v[184:187], v[148:151]
    ds_read_b128 v[200:203], v244 offset:976
    v_cvt_pk_bf16_f32 v161, v218, v222
    v_mfma_f32_16x16x32_bf16 v[152:155], v[60:63], v[184:187], v[152:155]
    v_cvt_pk_bf16_f32 v163, v219, v223
    s_waitcnt lgkmcnt(4)
    v_mfma_f32_16x16x32_bf16 v[148:151], v[32:35], v[188:191], v[148:151]
    ds_read_b128 v[176:179], v244 offset:1952
    v_cvt_pk_bf16_f32 v240, v228, v4
    v_mfma_f32_16x16x32_bf16 v[152:155], v[64:67], v[188:191], v[152:155]
    v_cvt_pk_bf16_f32 v241, v229, v5
    s_waitcnt lgkmcnt(4)
    v_mfma_f32_16x16x32_bf16 v[148:151], v[36:39], v[192:195], v[148:151]
    ds_read_b128 v[180:183], v244 offset:1888
    v_cvt_pk_bf16_f32 v242, v230, v6
    v_mfma_f32_16x16x32_bf16 v[148:151], v[156:159], v[80:83], v[148:151]
    v_cvt_pk_bf16_f32 v243, v231, v7
    v_mfma_f32_16x16x32_bf16 v[148:151], v[160:163], v[84:87], v[148:151]
    v_mfma_f32_16x16x32_bf16 v[152:155], v[68:71], v[192:195], v[152:155]
    s_waitcnt lgkmcnt(4)
    v_mfma_f32_16x16x32_bf16 v[152:155], v[8:11], v[172:175], v[152:155]
    ds_read_b128 v[184:187], v244 offset:1824
    v_mfma_f32_16x16x32_bf16 v[140:143], v[40:43], v[172:175], v[140:143]
    s_waitcnt lgkmcnt(4)
    v_mfma_f32_16x16x32_bf16 v[208:211], v[196:199], v[120:123], 0
    ds_read_b128 v[188:191], v244 offset:1760
    v_mfma_f32_16x16x32_bf16 v[212:215], v[196:199], v[124:127], 0
    v_mfma_f32_16x16x32_bf16 v[216:219], v[196:199], v[128:131], 0
    ds_write_b128 v245, v[148:151] offset:8256
    v_mfma_f32_16x16x32_bf16 v[228:231], v[196:199], v[132:135], 0
    ds_write_b32 v249, v247 offset:80
    v_mfma_f32_16x16x32_bf16 v[152:155], v[72:75], v[196:199], v[152:155]
    s_waitcnt lgkmcnt(6)
    v_mfma_f32_16x16x32_bf16 v[220:223], v[200:203], v[124:127], 0
    ds_read_b128 v[192:195], v244 offset:1696
    v_mfma_f32_16x16x32_bf16 v[4:7], v[200:203], v[136:139], 0
    v_mfma_f32_16x16x32_bf16 v[144:147], v[76:79], v[196:199], 0
    v_mfma_f32_16x16x32_bf16 v[152:155], v[156:159], v[88:91], v[152:155]
    ds_read_b32 v250, v246 offset:16
    v_mfma_f32_16x16x32_bf16 v[152:155], v[160:163], v[92:95], v[152:155]
    s_waitcnt lgkmcnt(7)
    v_mfma_f32_16x16x32_bf16 v[152:155], v[12:15], v[176:179], v[152:155]
    ds_read_b128 v[172:175], v244 offset:1632
    v_cvt_pk_bf16_f32 v164, v208, v212
    v_mfma_f32_16x16x32_bf16 v[140:143], v[44:47], v[176:179], v[140:143]
    v_cvt_pk_bf16_f32 v166, v209, v213
    s_waitcnt lgkmcnt(7)
    v_mfma_f32_16x16x32_bf16 v[152:155], v[16:19], v[180:183], v[152:155]
    ds_read_b128 v[176:179], v244 offset:1568
    v_cvt_pk_bf16_f32 v168, v210, v214
    v_mfma_f32_16x16x32_bf16 v[140:143], v[48:51], v[180:183], v[140:143]
    v_cvt_pk_bf16_f32 v170, v211, v215
    s_waitcnt lgkmcnt(7)
    s_waitcnt lgkmcnt(2)
    v_readfirstlane_b32 s5, v250
    v_mfma_f32_16x16x32_bf16 v[152:155], v[20:23], v[184:187], v[152:155]
    s_cmp_eq_u32 s5, 0
    s_cbranch_scc1 L_uslow4
L_uok4:
    ds_read_b128 v[180:183], v244 offset:2528
    v_cvt_pk_bf16_f32 v165, v216, v220
    v_mfma_f32_16x16x32_bf16 v[140:143], v[52:55], v[184:187], v[140:143]
    v_cvt_pk_bf16_f32 v167, v217, v221
    v_mfma_f32_16x16x32_bf16 v[152:155], v[24:27], v[188:191], v[152:155]
    ds_read_b128 v[196:199], v244 offset:1504
    v_cvt_pk_bf16_f32 v169, v218, v222
    v_mfma_f32_16x16x32_bf16 v[140:143], v[56:59], v[188:191], v[140:143]
    v_cvt_pk_bf16_f32 v171, v219, v223
    v_mfma_f32_16x16x32_bf16 v[152:155], v[28:31], v[192:195], v[152:155]
    ds_read_b128 v[200:203], v244 offset:1488
    v_cvt_pk_bf16_f32 v252, v228, v4
    v_mfma_f32_16x16x32_bf16 v[140:143], v[60:63], v[192:195], v[140:143]
    v_cvt_pk_bf16_f32 v253, v229, v5
    s_waitcnt lgkmcnt(4)
    v_mfma_f32_16x16x32_bf16 v[152:155], v[32:35], v[172:175], v[152:155]
    ds_read_b128 v[184:187], v244 offset:2464
    v_cvt_pk_bf16_f32 v254, v230, v6
    v_mfma_f32_16x16x32_bf16 v[140:143], v[64:67], v[172:175], v[140:143]
    v_cvt_pk_bf16_f32 v255, v231, v7
    s_waitcnt lgkmcnt(4)
    v_mfma_f32_16x16x32_bf16 v[152:155], v[36:39], v[176:179], v[152:155]
    ds_read_b128 v[188:191], v244 offset:2400
    v_mfma_f32_16x16x32_bf16 v[152:155], v[164:167], v[80:83], v[152:155]
    v_mfma_f32_16x16x32_bf16 v[152:155], v[168:171], v[84:87], v[152:155]
    v_mfma_f32_16x16x32_bf16 v[140:143], v[68:71], v[176:179], v[140:143]
    s_waitcnt lgkmcnt(4)
    v_mfma_f32_16x16x32_bf16 v[140:143], v[8:11], v[180:183], v[140:143]
    ds_read_b128 v[192:195], v244 offset:2336
    v_mfma_f32_16x16x32_bf16 v[144:147], v[40:43], v[180:183], v[144:147]
    s_waitcnt lgkmcnt(4)
    v_mfma_f32_16x16x32_bf16 v[208:211], v[196:199], v[120:123], 0
    ds_read_b128 v[172:175], v244 offset:2272
    v_mfma_f32_16x16x32_bf16 v[212:215], v[196:199], v[124:127], 0
    v_mfma_f32_16x16x32_bf16 v[216:219], v[196:199], v[128:131], 0
    ds_write_b128 v245, v[152:155] offset:12384
    v_mfma_f32_16x16x32_bf16 v[228:231], v[196:199], v[132:135], 0
    ds_write_b32 v249, v247 offset:96
    v_mfma_f32_16x16x32_bf16 v[140:143], v[72:75], v[196:199], v[140:143]
    s_waitcnt lgkmcnt(6)
    v_mfma_f32_16x16x32_bf16 v[220:223], v[200:203], v[124:127], 0
    ds_read_b128 v[176:179], v244 offset:2208
    v_mfma_f32_16x16x32_bf16 v[4:7], v[200:203], v[136:139], 0
    v_mfma_f32_16x16x32_bf16 v[148:151], v[76:79], v[196:199], 0
    v_mfma_f32_16x16x32_bf16 v[140:143], v[156:159], v[96:99], v[140:143]
    v_mfma_f32_16x16x32_bf16 v[140:143], v[160:163], v[100:103], v[140:143]
    v_mfma_f32_16x16x32_bf16 v[140:143], v[164:167], v[88:91], v[140:143]
    v_cvt_pk_bf16_f32 v232, v208, v212
    v_mfma_f32_16x16x32_bf16 v[140:143], v[168:171], v[92:95], v[140:143]
    ds_read_b32 v250, v246 offset:20
    v_cvt_pk_bf16_f32 v234, v209, v213
    v_mfma_f32_16x16x32_bf16 v[140:143], v[240:243], v[104:107], v[140:143]
    v_cvt_pk_bf16_f32 v236, v210, v214
    s_waitcnt lgkmcnt(7)
    v_mfma_f32_16x16x32_bf16 v[140:143], v[12:15], v[184:187], v[140:143]
    ds_read_b128 v[180:183], v244 offset:2144
    v_cvt_pk_bf16_f32 v238, v211, v215
    v_mfma_f32_16x16x32_bf16 v[144:147], v[44:47], v[184:187], v[144:147]
    v_cvt_pk_bf16_f32 v233, v216, v220
    s_waitcnt lgkmcnt(7)
    v_mfma_f32_16x16x32_bf16 v[140:143], v[16:19], v[188:191], v[140:143]
    ds_read_b128 v[184:187], v244 offset:2080
    v_cvt_pk_bf16_f32 v235, v217, v221
    v_mfma_f32_16x16x32_bf16 v[144:147], v[48:51], v[188:191], v[144:147]
    v_cvt_pk_bf16_f32 v237, v218, v222
    s_waitcnt lgkmcnt(7)
    s_waitcnt lgkmcnt(2)
    v_readfirstlane_b32 s5, v250
    v_mfma_f32_16x16x32_bf16 v[140:143], v[20:23], v[192:195], v[140:143]
    s_cmp_eq_u32 s5, 0
    s_cbranch_scc1 L_uslow5
L_uok5:
    ds_read_b128 v[188:191], v244 offset:3040
    v_cvt_pk_bf16_f32 v239, v219, v223
    v_mfma_f32_16x16x32_bf16 v[144:147], v[52:55], v[192:195], v[144:147]
    v_cvt_pk_bf16_f32 v204, v228, v4
    v_mfma_f32_16x16x32_bf16 v[140:143], v[24:27], v[172:175], v[140:143]
    ds_read_b128 v[196:199], v244 offset:2016
    v_cvt_pk_bf16_f32 v205, v229, v5
    v_mfma_f32_16x16x32_bf16 v[144:147], v[56:59], v[172:175], v[144:147]
    v_cvt_pk_bf16_f32 v206, v230, v6
    v_mfma_f32_16x16x32_bf16 v[140:143], v[28:31], v[176:179], v[140:143]
    ds_read_b128 v[200:203], v244 offset:2000
    v_cvt_pk_bf16_f32 v207, v231, v7
    v_mfma_f32_16x16x32_bf16 v[144:147], v[60:63], v[176:179], v[144:147]
    s_waitcnt lgkmcnt(4)
    v_mfma_f32_16x16x32_bf16 v[140:143], v[32:35], v[180:183], v[140:143]
    ds_read_b128 v[192:195], v244 offset:2976
    v_mfma_f32_16x16x32_bf16 v[144:147], v[64:67], v[180:183], v[144:147]
    s_waitcnt lgkmcnt(4)
    v_mfma_f32_16x16x32_bf16 v[140:143], v[36:39], v[184:187], v[140:143]
    ds_read_b128 v[172:175], v244 offset:2912
    v_mfma_f32_16x16x32_bf16 v[140:143], v[232:235], v[80:83], v[140:143]
    v_mfma_f32_16x16x32_bf16 v[140:143], v[236:239], v[84:87], v[140:143]
    v_mfma_f32_16x16x32_bf16 v[144:147], v[68:71], v[184:187], v[144:147]
    s_waitcnt lgkmcnt(4)
    v_mfma_f32_16x16x32_bf16 v[144:147], v[8:11], v[188:191], v[144:147]
    ds_read_b128 v[176:179], v244 offset:2848
    v_mfma_f32_16x16x32_bf16 v[148:151], v[40:43], v[188:191], v[148:151]
    s_waitcnt lgkmcnt(4)
    v_mfma_f32_16x16x32_bf16 v[208:211], v[196:199], v[120:123], 0
    ds_read_b128 v[180:183], v244 offset:2784
    v_mfma_f32_16x16x32_bf16 v[212:215], v[196:199], v[124:127], 0
    v_mfma_f32_16x16x32_bf16 v[216:219], v[196:199], v[128:131], 0
    ds_write_b128 v245, v[140:143] offset:16512
    v_mfma_f32_16x16x32_bf16 v[228:231], v[196:199], v[132:135], 0
    ds_write_b32 v249, v247 offset:112
    v_mfma_f32_16x16x32_bf16 v[144:147], v[72:75], v[196:199], v[144:147]
    s_waitcnt lgkmcnt(6)
    v_mfma_f32_16x16x32_bf16 v[220:223], v[200:203], v[124:127], 0
    ds_read_b128 v[184:187], v244 offset:2720
    v_mfma_f32_16x16x32_bf16 v[4:7], v[200:203], v[136:139], 0
    v_mfma_f32_16x16x32_bf16 v[152:155], v[76:79], v[196:199], 0
    v_mfma_f32_16x16x32_bf16 v[144:147], v[164:167], v[96:99], v[144:147]
    v_mfma_f32_16x16x32_bf16 v[144:147], v[168:171], v[100:103], v[144:147]
    v_mfma_f32_16x16x32_bf16 v[144:147], v[232:235], v[88:91], v[144:147]
    v_cvt_pk_bf16_f32 v156, v208, v212
    v_mfma_f32_16x16x32_bf16 v[144:147], v[236:239], v[92:95], v[144:147]
    v_cvt_pk_bf16_f32 v158, v209, v213
    v_mfma_f32_16x16x32_bf16 v[144:147], v[240:243], v[108:111], v[144:147]
    ds_read_b32 v250, v246 offset:24
    v_cvt_pk_bf16_f32 v160, v210, v214
    v_mfma_f32_16x16x32_bf16 v[144:147], v[252:255], v[104:107], v[144:147]
    v_cvt_pk_bf16_f32 v162, v211, v215
    s_waitcnt lgkmcnt(7)
    v_mfma_f32_16x16x32_bf16 v[144:147], v[12:15], v[192:195], v[144:147]
    ds_read_b128 v[188:191], v244 offset:2656
    v_cvt_pk_bf16_f32 v157, v216, v220
    v_mfma_f32_16x16x32_bf16 v[148:151], v[44:47], v[192:195], v[148:151]
    v_cvt_pk_bf16_f32 v159, v217, v221
    s_waitcnt lgkmcnt(7)
    v_mfma_f32_16x16x32_bf16 v[144:147], v[16:19], v[172:175], v[144:147]
    ds_read_b128 v[192:195], v244 offset:2592
    v_cvt_pk_bf16_f32 v161, v218, v222
    v_mfma_f32_16x16x32_bf16 v[148:151], v[48:51], v[172:175], v[148:151]
    v_cvt_pk_bf16_f32 v163, v219, v223
    s_waitcnt lgkmcnt(7)
    s_waitcnt lgkmcnt(2)
    v_readfirstlane_b32 s5, v250
    v_mfma_f32_16x16x32_bf16 v[144:147], v[20:23], v[176:179], v[144:147]
    s_cmp_eq_u32 s5, 0
    s_cbranch_scc1 L_uslow6
L_uok6:
    ds_read_b128 v[172:175], v244 offset:3552
    v_cvt_pk_bf16_f32 v224, v228, v4
    v_mfma_f32_16x16x32_bf16 v[148:151], v[52:55], v[176:179], v[148:151]
    v_cvt_pk_bf16_f32 v225, v229, v5
    v_mfma_f32_16x16x32_bf16 v[144:147], v[24:27], v[180:183], v[144:147]
    ds_read_b128 v[196:199], v244 offset:2528
    v_cvt_pk_bf16_f32 v226, v230, v6
    v_mfma_f32_16x16x32_bf16 v[148:151], v[56:59], v[180:183], v[148:151]
    v_cvt_pk_bf16_f32 v227, v231, v7
    v_mfma_f32_16x16x32_bf16 v[144:147], v[28:31], v[184:187], v[144:147]
    ds_read_b128 v[200:203], v244 offset:2512
    v_mfma_f32_16x16x32_bf16 v[148:151], v[60:63], v[184:187], v[148:151]
    s_waitcnt lgkmcnt(4)
    v_mfma_f32_16x16x32_bf16 v[144:147], v[32:35], v[188:191], v[144:147]
    ds_read_b128 v[176:179], v244 offset:3488
    v_mfma_f32_16x16x32_bf16 v[148:151], v[64:67], v[188:191], v[148:151]
    s_waitcnt lgkmcnt(4)
    v_mfma_f32_16x16x32_bf16 v[144:147], v[36:39], v[192:195], v[144:147]
    ds_read_b128 v[180:183], v244 offset:3424
    v_mfma_f32_16x16x32_bf16 v[144:147], v[156:159], v[80:83], v[144:147]
    v_mfma_f32_16x16x32_bf16 v[144:147], v[160:163], v[84:87], v[144:147]
    v_mfma_f32_16x16x32_bf16 v[148:151], v[68:71], v[192:195], v[148:151]
    s_waitcnt lgkmcnt(4)
    v_mfma_f32_16x16x32_bf16 v[148:151], v[8:11], v[172:175], v[148:151]
    ds_read_b128 v[184:187], v244 offset:3360
    v_mfma_f32_16x16x32_bf16 v[152:155], v[40:43], v[172:175], v[152:155]
    s_waitcnt lgkmcnt(4)
    v_mfma_f32_16x16x32_bf16 v[208:211], v[196:199], v[120:123], 0
    ds_read_b128 v[188:191], v244 offset:3296
    v_mfma_f32_16x16x32_bf16 v[212:215], v[196:199], v[124:127], 0
    v_mfma_f32_16x16x32_bf16 v[216:219], v[196:199], v[128:131], 0
    ds_write_b128 v245, v[144:147] offset:20640
    v_mfma_f32_16x16x32_bf16 v[148:151], v[72:75], v[196:199], v[148:151]
    ds_write_b32 v249, v247 offset:128
    s_waitcnt lgkmcnt(6)
    v_mfma_f32_16x16x32_bf16 v[220:223], v[200:203], v[124:127], 0
    ds_read_b128 v[192:195], v244 offset:3232
    v_mfma_f32_16x16x32_bf16 v[148:151], v[232:235], v[96:99], v[148:151]
    v_mfma_f32_16x16x32_bf16 v[148:151], v[236:239], v[100:103], v[148:151]
    v_mfma_f32_16x16x32_bf16 v[148:151], v[156:159], v[88:91], v[148:151]
    v_mfma_f32_16x16x32_bf16 v[148:151], v[160:163], v[92:95], v[148:151]
    v_cvt_pk_bf16_f32 v164, v208, v212
    v_mfma_f32_16x16x32_bf16 v[148:151], v[240:243], v[112:115], v[148:151]
    v_cvt_pk_bf16_f32 v166, v209, v213
    v_mfma_f32_16x16x32_bf16 v[148:151], v[252:255], v[108:111], v[148:151]
    ds_read_b32 v250, v246 offset:28
    v_cvt_pk_bf16_f32 v168, v210, v214
    v_mfma_f32_16x16x32_bf16 v[148:151], v[204:207], v[104:107], v[148:151]
    v_cvt_pk_bf16_f32 v170, v211, v215
    s_waitcnt lgkmcnt(7)
    v_mfma_f32_16x16x32_bf16 v[148:151], v[12:15], v[176:179], v[148:151]
    ds_read_b128 v[172:175], v244 offset:3168
    v_cvt_pk_bf16_f32 v165, v216, v220
    v_mfma_f32_16x16x32_bf16 v[152:155], v[44:47], v[176:179], v[152:155]
    v_cvt_pk_bf16_f32 v167, v217, v221
    s_waitcnt lgkmcnt(7)
    v_mfma_f32_16x16x32_bf16 v[148:151], v[16:19], v[180:183], v[148:151]
    ds_read_b128 v[176:179], v244 offset:3104
    v_cvt_pk_bf16_f32 v169, v218, v222
    v_mfma_f32_16x16x32_bf16 v[152:155], v[48:51], v[180:183], v[152:155]
    v_cvt_pk_bf16_f32 v171, v219, v223
    s_waitcnt lgkmcnt(7)
    s_waitcnt lgkmcnt(2)
    v_readfirstlane_b32 s5, v250
    v_mfma_f32_16x16x32_bf16 v[148:151], v[20:23], v[184:187], v[148:151]
    s_cmp_eq_u32 s5, 0
    s_cbranch_scc1 L_uslow7
L_uok7:
    ds_read_b128 v[180:183], v244 offset:4064
    v_mfma_f32_16x16x32_bf16 v[152:155], v[52:55], v[184:187], v[152:155]
    v_mfma_f32_16x16x32_bf16 v[148:151], v[24:27], v[188:191], v[148:151]
    ds_read_b128 v[196:199], v244 offset:3040
    v_mfma_f32_16x16x32_bf16 v[152:155], v[56:59], v[188:191], v[152:155]
    v_mfma_f32_16x16x32_bf16 v[148:151], v[28:31], v[192:195], v[148:151]
    ds_read_b128 v[200:203], v244 offset:3024
    v_mfma_f32_16x16x32_bf16 v[152:155], v[60:63], v[192:195], v[152:155]
    s_waitcnt lgkmcnt(4)
    v_mfma_f32_16x16x32_bf16 v[148:151], v[32:35], v[172:175], v[148:151]
    ds_read_b128 v[184:187], v244 offset:4000
    v_mfma_f32_16x16x32_bf16 v[152:155], v[64:67], v[172:175], v[152:155]
    s_waitcnt lgkmcnt(4)
    v_mfma_f32_16x16x32_bf16 v[148:151], v[36:39], v[176:179], v[148:151]
    ds_read_b128 v[188:191], v244 offset:3936
    v_mfma_f32_16x16x32_bf16 v[148:151], v[164:167], v[80:83], v[148:151]
    v_mfma_f32_16x16x32_bf16 v[148:151], v[168:171], v[84:87], v[148:151]
    v_mfma_f32_16x16x32_bf16 v[152:155], v[68:71], v[176:179], v[152:155]
    s_waitcnt lgkmcnt(4)
    v_mfma_f32_16x16x32_bf16 v[152:155], v[8:11], v[180:183], v[152:155]
    ds_read_b128 v[192:195], v244 offset:3872
    s_waitcnt lgkmcnt(4)
    v_mfma_f32_16x16x32_bf16 v[208:211], v[196:199], v[120:123], 0
    ds_read_b128 v[172:175], v244 offset:3808
    v_mfma_f32_16x16x32_bf16 v[212:215], v[196:199], v[124:127], 0
    v_mfma_f32_16x16x32_bf16 v[216:219], v[196:199], v[128:131], 0
    v_mfma_f32_16x16x32_bf16 v[152:155], v[72:75], v[196:199], v[152:155]
    ds_write_b128 v245, v[148:151] offset:24768
    s_waitcnt lgkmcnt(5)
    v_mfma_f32_16x16x32_bf16 v[220:223], v[200:203], v[124:127], 0
    ds_read_b128 v[176:179], v244 offset:3744
    ds_write_b32 v249, v247 offset:144
    v_mfma_f32_16x16x32_bf16 v[152:155], v[156:159], v[96:99], v[152:155]
    v_mfma_f32_16x16x32_bf16 v[152:155], v[160:163], v[100:103], v[152:155]
    v_mfma_f32_16x16x32_bf16 v[152:155], v[164:167], v[88:91], v[152:155]
    v_mfma_f32_16x16x32_bf16 v[152:155], v[168:171], v[92:95], v[152:155]
    v_cvt_pk_bf16_f32 v232, v208, v212
    v_cvt_pk_bf16_f32 v234, v209, v213
    v_mfma_f32_16x16x32_bf16 v[152:155], v[240:243], v[116:119], v[152:155]
    v_cvt_pk_bf16_f32 v236, v210, v214
    v_cvt_pk_bf16_f32 v238, v211, v215
    v_mfma_f32_16x16x32_bf16 v[152:155], v[252:255], v[112:115], v[152:155]
    v_cvt_pk_bf16_f32 v233, v216, v220
    v_cvt_pk_bf16_f32 v235, v217, v221
    v_mfma_f32_16x16x32_bf16 v[152:155], v[204:207], v[108:111], v[152:155]
    v_cvt_pk_bf16_f32 v237, v218, v222
    v_cvt_pk_bf16_f32 v239, v219, v223
    v_mfma_f32_16x16x32_bf16 v[152:155], v[224:227], v[104:107], v[152:155]
    s_waitcnt lgkmcnt(6)
    v_mfma_f32_16x16x32_bf16 v[152:155], v[12:15], v[184:187], v[152:155]
    ds_read_b128 v[180:183], v244 offset:3680
    s_waitcnt lgkmcnt(6)
    v_mfma_f32_16x16x32_bf16 v[152:155], v[16:19], v[188:191], v[152:155]
    ds_read_b128 v[184:187], v244 offset:3616
    s_waitcnt lgkmcnt(6)
    v_mfma_f32_16x16x32_bf16 v[152:155], v[20:23], v[192:195], v[152:155]
    s_waitcnt lgkmcnt(5)
    v_mfma_f32_16x16x32_bf16 v[152:155], v[24:27], v[172:175], v[152:155]
    s_waitcnt lgkmcnt(3)
    v_mfma_f32_16x16x32_bf16 v[152:155], v[28:31], v[176:179], v[152:155]
    s_waitcnt lgkmcnt(1)
    v_mfma_f32_16x16x32_bf16 v[152:155], v[32:35], v[180:183], v[152:155]
    s_waitcnt lgkmcnt(0)
    v_mfma_f32_16x16x32_bf16 v[152:155], v[36:39], v[184:187], v[152:155]
    v_mfma_f32_16x16x32_bf16 v[152:155], v[232:235], v[80:83], v[152:155]
    v_mfma_f32_16x16x32_bf16 v[152:155], v[236:239], v[84:87], v[152:155]
    s_nop 7
    ds_write_b128 v245, v[152:155] offset:28896
    ds_write_b32 v249, v247 offset:160
    v_mov_b32 v60, s18
    v_mov_b32 v61, s19
    v_mov_b32 v62, s20
    v_mov_b32 v63, s21
    global_load_dwordx4 v[56:59], v2, s[42:43] sc1
    s_mov_b64 exec, s[56:57]
    global_load_dwordx4 v[60:63], v3, s[42:43] sc1
    s_mov_b64 exec, -1
    v_lshrrev_b32 v9, 5, v1
    s_lshl_b32 s5, s45, 3
    v_lshl_add_u32 v24, v9, 2, s5
    v_add_u32 v24, v24, v246
    v_bfe_u32 v25, v1, 4, 1
    s_mov_b32 s54, 1048576
L_st_11:
    ds_read_b128 v[28:31], v246 offset:176
    ds_read_b128 v[32:35], v246 offset:160
    ds_read_b32 v26, v24 offset:192
    s_sub_u32 s54, s54, 1
    s_cbranch_scc1 L_sto_12
    s_waitcnt lgkmcnt(0)
    v_and_b32 v28, v28, v29
    v_and_b32 v30, v30, v31
    v_and_b32 v32, v32, v33
    v_and_b32 v34, v34, v35
    v_and_b32 v28, v28, v30
    v_and_b32 v32, v32, v34
    v_and_b32 v28, v28, v32
    v_cmp_eq_u32 vcc, 0, v28
    s_cbranch_vccnz L_st_11
L_sto_12:
    v_and_b32 v27, 0x7ff, v26
    v_sub_u32 v27, 2047, v27
    v_mul_u32_u24 v28, 9216, v25
    v_lshl_add_u32 v28, v27, 1, v28
    v_add_u32 v28, 116096, v28
    v_lshlrev_b32 v29, 3, v27
    v_lshl_add_u32 v29, v25, 2, v29
    v_lshrrev_b32 v30, 7, v27
    v_mul_u32_u24 v30, 2064, v30
    v_bfe_u32 v31, v27, 4, 3
    v_lshl_add_u32 v30, v31, 6, v30
    v_lshrrev_b32 v31, 2, v27
    v_lshrrev_b32 v32, 5, v27
    v_add_u32 v31, v31, v32
    v_and_b32 v31, 3, v31
    v_lshl_add_u32 v30, v31, 4, v30
    v_and_b32 v31, 3, v27
    v_lshl_add_u32 v30, v31, 2, v30
    v_lshl_add_u32 v30, v25, 10, v30
    ds_read_u16 v36, v28
    ds_read_u16 v37, v28 offset:4608
    ds_read_b32 v38, v29 offset:33024
    ds_read_b32 v40, v30
    ds_read_b32 v41, v30 offset:512
    s_lshl_b32 s5, s44, 3
    v_mul_u32_u24 v42, 1280, v27
    v_lshl_add_u32 v42, v25, 2, v42
    v_add_u32 v42, s5, v42
    v_not_b32 v31, v26
    v_ashrrev_i32 v31, 31, v31
    v_or_b32 v31, 0x80000000, v31
    v_xor_b32 v31, v26, v31
    v_and_b32 v31, 0xffff0000, v31
    v_mul_f32 v31, 0xbfb8aa3b, v31
    v_exp_f32 v31, v31
    s_waitcnt lgkmcnt(0)
    v_add_f32 v31, 1.0, v31
    v_rcp_f32 v43, v31
    v_lshlrev_b32 v36, 16, v36
    v_lshlrev_b32 v37, 16, v37
    v_and_b32 v39, 0xffff0000, v38
    v_lshlrev_b32 v38, 16, v38
    s_mov_b32 s54, 1048576
L_par_13:
    s_waitcnt vmcnt(0)
    v_xor_b32 v44, s18, v56
    v_xor_b32 v45, s19, v57
    v_xor_b32 v46, s20, v58
    v_xor_b32 v47, s21, v59
    v_xor_b32 v48, s18, v60
    v_xor_b32 v49, s19, v61
    v_xor_b32 v50, s20, v62
    v_xor_b32 v51, s21, v63
    v_or3_b32 v52, v44, v45, v46
    v_or3_b32 v53, v47, v48, v49
    v_or3_b32 v52, v52, v50, v51
    v_or_b32 v52, v52, v53
    v_and_b32 v52, 0xff, v52
    v_cmp_ne_u32 vcc, 0, v52
    s_cbranch_vccz L_paro_14
    s_sub_u32 s54, s54, 1
    s_cbranch_scc1 L_paro_14
    s_and_b64 s[58:59], vcc, s[56:57]
    s_mov_b64 exec, vcc
    global_load_dwordx4 v[56:59], v2, s[42:43] sc1
    s_or_b64 exec, s[58:59], 1
    global_load_dwordx4 v[60:63], v3, s[42:43] sc1
    s_mov_b64 exec, -1
    s_branch L_par_13
L_paro_14:
    v_add_f32 v44, v44, v48
    v_add_f32 v45, v45, v49
    v_add_f32 v46, v46, v50
    v_add_f32 v47, v47, v51
    s_nop 0
    v_permlane16_swap_b32 v44, v46
    v_permlane16_swap_b32 v45, v47
    v_add_f32 v44, v44, v46
    v_add_f32 v45, v45, v47
    s_nop 0
    v_add_f32_dpp v44, v44, v44 row_shr:1 row_mask:0xf bank_mask:0xf bound_ctrl:0
    v_add_f32_dpp v45, v45, v45 row_shr:1 row_mask:0xf bank_mask:0xf bound_ctrl:0
    s_nop 0
    v_add_f32_dpp v44, v44, v44 row_shr:2 row_mask:0xf bank_mask:0xf bound_ctrl:0
    v_add_f32_dpp v45, v45, v45 row_shr:2 row_mask:0xf bank_mask:0xf bound_ctrl:0
    s_nop 0
    v_add_f32_dpp v44, v44, v44 row_shr:4 row_mask:0xf bank_mask:0xf bound_ctrl:0
    v_add_f32_dpp v45, v45, v45 row_shr:4 row_mask:0xf bank_mask:0xf bound_ctrl:0
    s_nop 0
    v_add_f32_dpp v44, v44, v44 row_shr:8 row_mask:0xf bank_mask:0xf bound_ctrl:0
    v_add_f32_dpp v45, v45, v45 row_shr:8 row_mask:0xf bank_mask:0xf bound_ctrl:0
    v_fma_f32 v44, v44, v43, v36
    v_fma_f32 v45, v45, v43, v37
    v_mul_f32 v46, 0xbfb8aa3b, v44
    v_mul_f32 v47, 0xbfb8aa3b, v45
    v_exp_f32 v46, v46
    v_exp_f32 v47, v47
    v_mul_f32 v44, v44, v40
    v_mul_f32 v45, v45, v41
    v_add_f32 v46, 1.0, v46
    v_add_f32 v47, 1.0, v47
    v_rcp_f32 v46, v46
    v_rcp_f32 v47, v47
    s_mov_b32 exec_lo, 0x80008000
    s_mov_b32 exec_hi, 0x80008000
    v_fma_f32 v44, v44, v46, v38
    v_fma_f32 v45, v45, v47, v39
    v_cvt_pk_bf16_f32 v44, v44, v45
    global_store_dword v42, v44, s[40:41]
    s_endpgm
L_fast01:
    ds_read_b128 v[172:175], v244 offset:480
    ds_read_b128 v[176:179], v244 offset:416
    ds_read_b64 v[12:13], v234 offset:320
    ds_read_b64 v[14:15], v240 offset:320
    ds_read_b64 v[44:45], v234 offset:2880
    ds_read_b64 v[46:47], v240 offset:2880
    ds_read_b128 v[180:183], v244 offset:352
    ds_read_b64 v[16:17], v234 offset:640
    ds_read_b64 v[18:19], v240 offset:640
    ds_read_b64 v[48:49], v234 offset:3200
    ds_read_b64 v[50:51], v240 offset:3200
    ds_read_b128 v[184:187], v244 offset:288
    ds_read_b128 v[188:191], v244 offset:224
    s_waitcnt lgkmcnt(12)
    v_mfma_f32_16x16x32_bf16 v[140:143], v[8:11], v[172:175], 0
    ds_read_b32 v250, v246 offset:4
    ds_read_b128 v[192:195], v244 offset:160
    ds_read_b64 v[20:21], v234 offset:960
    ds_read_b64 v[22:23], v240 offset:960
    v_and_b32 v76, v76, v120
    v_and_b32 v77, v77, v121
    v_mfma_f32_16x16x32_bf16 v[144:147], v[40:43], v[172:175], 0
    ds_read_b64 v[52:53], v234 offset:3520
    ds_read_b64 v[54:55], v240 offset:3520
    v_and_b32 v78, v78, v122
    s_waitcnt lgkmcnt(14)
    v_mfma_f32_16x16x32_bf16 v[140:143], v[12:15], v[176:179], v[140:143]
    ds_read_b128 v[172:175], v244 offset:96
    ds_read_b64 v[24:25], v234 offset:1280
    ds_read_b64 v[26:27], v240 offset:1280
    v_and_b32 v79, v79, v123
    s_waitcnt lgkmcnt(14)
    v_mfma_f32_16x16x32_bf16 v[144:147], v[44:47], v[176:179], v[144:147]
    ds_read_b64 v[56:57], v234 offset:3840
    ds_read_b64 v[58:59], v240 offset:3840
    v_pk_lshlrev_b16 v76, 2, v76 op_sel_hi:[0,1]
    s_waitcnt lgkmcnt(14)
    v_mfma_f32_16x16x32_bf16 v[140:143], v[16:19], v[180:183], v[140:143]
    ds_read_b128 v[176:179], v244 offset:32
    ds_read_b64 v[28:29], v234 offset:1600
    ds_read_b64 v[30:31], v240 offset:1600
    v_pk_ashrrev_i16 v76, 15, v76 op_sel_hi:[0,1]
    v_pk_lshlrev_b16 v77, 2, v77 op_sel_hi:[0,1]
    s_waitcnt lgkmcnt(14)
    v_mfma_f32_16x16x32_bf16 v[144:147], v[48:51], v[180:183], v[144:147]
    ds_read_b64 v[60:61], v234 offset:4160
    ds_read_b64 v[62:63], v240 offset:4160
    v_pk_ashrrev_i16 v77, 15, v77 op_sel_hi:[0,1]
    s_waitcnt lgkmcnt(12)
    v_readfirstlane_b32 s5, v250
    v_mfma_f32_16x16x32_bf16 v[140:143], v[20:23], v[184:187], v[140:143]
    s_cmp_eq_u32 s5, 0
    s_cbranch_scc1 L_uslow1b
L_uok1b:
    ds_read_b128 v[180:183], v244 offset:992
    ds_read_b64 v[32:33], v234 offset:1920
    ds_read_b64 v[34:35], v240 offset:1920
    v_pk_lshlrev_b16 v78, 2, v78 op_sel_hi:[0,1]
    s_waitcnt lgkmcnt(13)
    v_mfma_f32_16x16x32_bf16 v[144:147], v[52:55], v[184:187], v[144:147]
    ds_read_b64 v[64:65], v234 offset:4480
    ds_read_b64 v[66:67], v240 offset:4480
    v_pk_ashrrev_i16 v78, 15, v78 op_sel_hi:[0,1]
    s_waitcnt lgkmcnt(12)
    v_mfma_f32_16x16x32_bf16 v[140:143], v[24:27], v[188:191], v[140:143]
    ds_read_b128 v[184:187], v244 offset:928
    ds_read_b64 v[36:37], v234 offset:2240
    ds_read_b64 v[38:39], v240 offset:2240
    v_pk_lshlrev_b16 v79, 2, v79 op_sel_hi:[0,1]
    v_pk_ashrrev_i16 v79, 15, v79 op_sel_hi:[0,1]
    s_waitcnt lgkmcnt(13)
    v_mfma_f32_16x16x32_bf16 v[144:147], v[56:59], v[188:191], v[144:147]
    ds_read_b64 v[68:69], v234 offset:4800
    ds_read_b64 v[70:71], v240 offset:4800
    v_pk_lshlrev_b16 v224, 2, v224 op_sel_hi:[0,1]
    s_waitcnt lgkmcnt(12)
    v_mfma_f32_16x16x32_bf16 v[140:143], v[28:31], v[192:195], v[140:143]
    ds_read_b128 v[188:191], v244 offset:864
    ds_write_b32 v209, v220 offset:5728
    ds_write_b16 v210, v221 offset:6176
    v_pk_ashrrev_i16 v224, 15, v224 op_sel_hi:[0,1]
    s_waitcnt lgkmcnt(13)
    v_mfma_f32_16x16x32_bf16 v[144:147], v[60:63], v[192:195], v[144:147]
    ds_write_b16_d16_hi v210, v221 offset:6240
    ds_read_b64 v[72:73], v234 offset:5120
    v_pk_lshlrev_b16 v225, 2, v225 op_sel_hi:[0,1]
    s_waitcnt lgkmcnt(12)
    v_mfma_f32_16x16x32_bf16 v[140:143], v[32:35], v[172:175], v[140:143]
    ds_read_b128 v[192:195], v244 offset:800
    ds_read_b64 v[74:75], v240 offset:5120
    ds_read_b64 v[80:81], v235 offset:5632
    v_pk_ashrrev_i16 v225, 15, v225 op_sel_hi:[0,1]
    v_pk_lshlrev_b16 v226, 2, v226 op_sel_hi:[0,1]
    s_waitcnt lgkmcnt(13)
    v_mfma_f32_16x16x32_bf16 v[144:147], v[64:67], v[172:175], v[144:147]
    ds_read_b64 v[82:83], v235 offset:5624
    ds_read_b64 v[84:85], v235 offset:5616
    v_pk_ashrrev_i16 v226, 15, v226 op_sel_hi:[0,1]
    s_waitcnt lgkmcnt(12)
    v_mfma_f32_16x16x32_bf16 v[140:143], v[36:39], v[176:179], v[140:143]
    ds_read_b128 v[172:175], v244 offset:736
    ds_read_b64 v[86:87], v235 offset:5608
    ds_read_b64 v[88:89], v235 offset:5760
    v_pk_lshlrev_b16 v227, 2, v227 op_sel_hi:[0,1]
    s_waitcnt lgkmcnt(13)
    v_mfma_f32_16x16x32_bf16 v[144:147], v[68:71], v[176:179], v[144:147]
    ds_read_b64 v[90:91], v235 offset:5752
    ds_read_b64 v[92:93], v235 offset:5744
    v_pk_ashrrev_i16 v227, 15, v227 op_sel_hi:[0,1]
    v_mfma_f32_16x16x32_bf16 v[144:147], v[8:11], v[180:183], v[144:147]
    ds_read_b32 v250, v246 offset:8
    ds_read_b128 v[176:179], v244 offset:672
    ds_read_b64 v[94:95], v235 offset:5736
    v_mfma_f32_16x16x32_bf16 v[148:151], v[40:43], v[180:183], 0
    ds_read_b64 v[96:97], v235 offset:5888
    ds_read_b64 v[98:99], v235 offset:5880
    v_mfma_f32_16x16x32_bf16 v[144:147], v[12:15], v[184:187], v[144:147]
    ds_read_b128 v[180:183], v244 offset:608
    ds_read_b64 v[100:101], v235 offset:5872
    v_readlane_b32 s6, v218, 63
    v_mfma_f32_16x16x32_bf16 v[148:151], v[44:47], v[184:187], v[148:151]
    ds_read_b64 v[102:103], v235 offset:5864
    ds_read2_b32 v[104:105], v236 offset0:4 offset1:3
    v_readlane_b32 s7, v223, 63
    s_waitcnt lgkmcnt(14)
    v_mfma_f32_16x16x32_bf16 v[144:147], v[16:19], v[188:191], v[144:147]
    ds_read_b128 v[184:187], v244 offset:544
    ds_write_b128 v245, v[140:143] offset:0
    ds_read2_b32 v[106:107], v236 offset0:2 offset1:1
    v_mfma_f32_16x16x32_bf16 v[148:151], v[48:51], v[188:191], v[148:151]
    ds_write_b32 v249, v247 offset:48
    ds_read2_b32 v[108:109], v236 offset0:20 offset1:19
    v_and_b32 v76, s7, v76
    s_waitcnt lgkmcnt(13)
    v_readfirstlane_b32 s5, v250
    v_mfma_f32_16x16x32_bf16 v[144:147], v[20:23], v[192:195], v[144:147]
    s_cmp_eq_u32 s5, 0
    s_cbranch_scc1 L_uslow2b
L_uok2b:
    ds_read_b128 v[188:191], v244 offset:1504
    ds_read2_b32 v[110:111], v236 offset0:18 offset1:17
    v_and_b32 v77, s7, v77
    v_mfma_f32_16x16x32_bf16 v[148:151], v[52:55], v[192:195], v[148:151]
    ds_read2_b32 v[112:113], v236 offset0:36 offset1:35
    ds_read2_b32 v[114:115], v236 offset0:34 offset1:33
    v_and_b32 v78, s7, v78
    v_mfma_f32_16x16x32_bf16 v[144:147], v[24:27], v[172:175], v[144:147]
    ds_read_b128 v[196:199], v244 offset:480
    ds_read2_b32 v[116:117], v236 offset0:52 offset1:51
    v_and_b32 v79, s7, v79
    v_mfma_f32_16x16x32_bf16 v[148:151], v[56:59], v[172:175], v[148:151]
    ds_read2_b32 v[118:119], v236 offset0:50 offset1:49
    s_waitcnt lgkmcnt(14)
    v_mfma_f32_16x16x32_bf16 v[144:147], v[28:31], v[176:179], v[144:147]
    ds_read_b128 v[200:203], v244 offset:464
    v_and_or_b32 v72, v224, s6, v72
    v_mfma_f32_16x16x32_bf16 v[148:151], v[60:63], v[176:179], v[148:151]
    v_and_or_b32 v73, v225, s6, v73
    v_mfma_f32_16x16x32_bf16 v[144:147], v[32:35], v[180:183], v[144:147]
    ds_read_b128 v[192:195], v244 offset:1440
    v_and_or_b32 v74, v226, s6, v74
    v_mfma_f32_16x16x32_bf16 v[148:151], v[64:67], v[180:183], v[148:151]
    v_and_or_b32 v75, v227, s6, v75
    s_waitcnt lgkmcnt(13)
    v_mfma_f32_16x16x32_bf16 v[144:147], v[36:39], v[184:187], v[144:147]
    ds_read_b128 v[172:175], v244 offset:1376
    v_mfma_f32_16x16x32_bf16 v[148:151], v[68:71], v[184:187], v[148:151]
    s_waitcnt lgkmcnt(3)
    s_branch L_join
L_uslow1a:
    s_mov_b32 s54, 1048576
L_us_15:
    ds_read_b32 v250, v246 offset:4
    s_waitcnt lgkmcnt(0)
    v_readfirstlane_b32 s5, v250
    s_sub_u32 s54, s54, 1
    s_cbranch_scc1 L_uso_16
    s_cmp_lt_u32 s5, 1
    s_cbranch_scc1 L_us_15
L_uso_16:
    s_branch L_uok1a
L_uslow2a:
    s_mov_b32 s54, 1048576
L_us_17:
    ds_read_b32 v250, v246 offset:8
    s_waitcnt lgkmcnt(0)
    v_readfirstlane_b32 s5, v250
    s_sub_u32 s54, s54, 1
    s_cbranch_scc1 L_uso_18
    s_cmp_lt_u32 s5, 1
    s_cbranch_scc1 L_us_17
L_uso_18:
    s_branch L_uok2a
L_uslow3:
    s_mov_b32 s54, 1048576
L_us_19:
    ds_read_b32 v250, v246 offset:12
    s_waitcnt lgkmcnt(0)
    v_readfirstlane_b32 s5, v250
    s_sub_u32 s54, s54, 1
    s_cbranch_scc1 L_uso_20
    s_cmp_lt_u32 s5, 1
    s_cbranch_scc1 L_us_19
L_uso_20:
    s_branch L_uok3
L_uslow4:
    s_mov_b32 s54, 1048576
L_us_21:
    ds_read_b32 v250, v246 offset:16
    s_waitcnt lgkmcnt(0)
    v_readfirstlane_b32 s5, v250
    s_sub_u32 s54, s54, 1
    s_cbranch_scc1 L_uso_22
    s_cmp_lt_u32 s5, 1
    s_cbranch_scc1 L_us_21
L_uso_22:
    s_branch L_uok4
L_uslow5:
    s_mov_b32 s54, 1048576
L_us_23:
    ds_read_b32 v250, v246 offset:20
    s_waitcnt lgkmcnt(0)
    v_readfirstlane_b32 s5, v250
    s_sub_u32 s54, s54, 1
    s_cbranch_scc1 L_uso_24
    s_cmp_lt_u32 s5, 1
    s_cbranch_scc1 L_us_23
L_uso_24:
    s_branch L_uok5
L_uslow6:
    s_mov_b32 s54, 1048576
L_us_25:
    ds_read_b32 v250, v246 offset:24
    s_waitcnt lgkmcnt(0)
    v_readfirstlane_b32 s5, v250
    s_sub_u32 s54, s54, 1
    s_cbranch_scc1 L_uso_26
    s_cmp_lt_u32 s5, 1
    s_cbranch_scc1 L_us_25
L_uso_26:
    s_branch L_uok6
L_uslow7:
    s_mov_b32 s54, 1048576
L_us_27:
    ds_read_b32 v250, v246 offset:28
    s_waitcnt lgkmcnt(0)
    v_readfirstlane_b32 s5, v250
    s_sub_u32 s54, s54, 1
    s_cbranch_scc1 L_uso_28
    s_cmp_lt_u32 s5, 1
    s_cbranch_scc1 L_us_27
L_uso_28:
    s_branch L_uok7
L_uslow1b:
    s_mov_b32 s54, 1048576
L_us_29:
    ds_read_b32 v250, v246 offset:4
    s_waitcnt lgkmcnt(0)
    v_readfirstlane_b32 s5, v250
    s_sub_u32 s54, s54, 1
    s_cbranch_scc1 L_uso_30
    s_cmp_lt_u32 s5, 1
    s_cbranch_scc1 L_us_29
L_uso_30:
    s_branch L_uok1b
L_uslow2b:
    s_mov_b32 s54, 1048576
L_us_31:
    ds_read_b32 v250, v246 offset:8
    s_waitcnt lgkmcnt(0)
    v_readfirstlane_b32 s5, v250
    s_sub_u32 s54, s54, 1
    s_cbranch_scc1 L_uso_32
    s_cmp_lt_u32 s5, 1
    s_cbranch_scc1 L_us_31
L_uso_32:
    s_branch L_uok2b
L_helper:
    s_setprio 0
    s_lshl_b32 s5, s45, 11
    s_add_u32 s5, s5, 4096
    v_lshl_add_u32 v92, v1, 5, s5
    s_lshl_b32 s5, s55, 11
    v_add_u32 v93, s5, v92
    s_waitcnt lgkmcnt(0)
    s_barrier
    global_load_dwordx4 v[8:11], v92, s[42:43] sc1
    global_load_dwordx4 v[12:15], v92, s[42:43] offset:16 sc1
    s_lshl_b32 s5, s45, 9
    s_add_u32 s5, s5, 116096
    v_lshl_add_u32 v91, v1, 3, s5
    v_lshrrev_b32 v2, 3, v1
    v_add_u32 v2, v2, v1
    v_and_b32 v2, 3, v2
    v_and_b32 v3, 28, v1
    v_add_u32 v2, v2, v3
    v_lshlrev_b32 v2, 4, v2
    v_lshrrev_b32 v3, 5, v1
    v_mul_u32_u24 v3, 2064, v3
    s_mul_i32 s5, s45, 4128
    v_add3_u32 v90, v2, v3, s5
    s_lshl_b32 s5, s45, 2
    v_add_u32 v89, s5, v246
    s_lshl_b32 s5, s45, 4
    v_add_u32 v87, s5, v246
    s_lshl_b32 s5, s45, 11
    s_add_u32 s5, s5, 33024
    v_lshl_add_u32 v86, v1, 5, s5
    s_lshl_b32 s5, s55, 9
    v_add_u32 v232, s5, v91
    s_mul_i32 s5, s55, 4128
    v_add_u32 v233, s5, v90
    s_lshl_b32 s5, s55, 2
    v_add_u32 v234, s5, v89
    s_lshl_b32 s5, s55, 4
    v_add_u32 v235, s5, v87
    s_lshl_b32 s5, s55, 11
    v_add_u32 v236, s5, v86
    v_and_b32 v88, 7, v1
    v_lshl_add_u32 v237, v88, 2, v246
    v_lshlrev_b32 v88, 4, v88
    v_add_u32 v88, 53248, v88
    s_lshl_b32 s5, s9, 7
    s_and_b32 s5, s5, 0x380
    v_add_u32 v88, s5, v88
    s_lshl_b32 s5, s45, 8
    s_add_u32 s5, s5, 160992
    v_add_u32 v238, s5, v4
    s_lshl_b32 s5, s55, 8
    v_add_u32 v239, s5, v238
    s_waitcnt vmcnt(2)
    v_lshlrev_b32 v112, 16, v96
    v_and_b32 v116, 0xffff0000, v96
    v_lshlrev_b32 v120, 16, v97
    v_and_b32 v124, 0xffff0000, v97
    v_lshlrev_b32 v113, 16, v98
    v_and_b32 v117, 0xffff0000, v98
    v_lshlrev_b32 v121, 16, v99
    v_and_b32 v125, 0xffff0000, v99
    v_lshlrev_b32 v114, 16, v100
    v_and_b32 v118, 0xffff0000, v100
    v_lshlrev_b32 v122, 16, v101
    v_and_b32 v126, 0xffff0000, v101
    v_lshlrev_b32 v115, 16, v102
    v_and_b32 v119, 0xffff0000, v102
    v_lshlrev_b32 v123, 16, v103
    v_and_b32 v127, 0xffff0000, v103
    s_mov_b32 s54, 1048576
    s_waitcnt vmcnt(0)
L_g_33:
    v_xor_b32 v2, s4, v9
    v_xor_b32 v3, s4, v11
    v_xor_b32 v5, s4, v13
    v_xor_b32 v6, s4, v15
    v_or3_b32 v2, v2, v3, v5
    v_or_b32 v2, v2, v6
    v_cmp_ne_u32 vcc, 0, v2
    s_cbranch_vccz L_go_34
    s_sub_u32 s54, s54, 1
    s_cbranch_scc1 L_go_34
    global_load_dwordx4 v[8:11], v92, s[42:43] sc1
    global_load_dwordx4 v[12:15], v92, s[42:43] offset:16 sc1
    s_waitcnt vmcnt(0)
    s_branch L_g_33
L_go_34:
    global_load_dwordx2 v[104:105], v95, s[16:17] offset:0
    global_load_dwordx2 v[106:107], v95, s[16:17] offset:1280
    global_load_dwordx2 v[108:109], v95, s[16:17] offset:2560
    global_load_dwordx2 v[110:111], v95, s[16:17] offset:3840
    global_load_dwordx4 v[16:19], v93, s[42:43] sc1
    global_load_dwordx4 v[20:23], v93, s[42:43] offset:16 sc1
    v_and_b32 v180, 0xffff0000, v8
    v_and_b32 v181, 0xffff0000, v10
    v_and_b32 v182, 0xffff0000, v12
    v_and_b32 v183, 0xffff0000, v14
    v_rcp_f32 v180, v180
    v_rcp_f32 v181, v181
    v_rcp_f32 v182, v182
    v_rcp_f32 v183, v183
    v_lshlrev_b32 v176, 16, v8
    v_lshlrev_b32 v177, 16, v10
    v_lshlrev_b32 v178, 16, v12
    v_lshlrev_b32 v179, 16, v14
    v_mul_f32 v176, v176, v180
    v_mul_f32 v177, v177, v181
    v_mul_f32 v178, v178, v182
    v_mul_f32 v179, v179, v183
    v_fma_f32 v128, v112, v180, -v176
    v_fma_f32 v129, v113, v181, -v177
    v_fma_f32 v130, v114, v182, -v178
    v_fma_f32 v131, v115, v183, -v179
    v_cvt_pk_bf16_f32 v24, v128, v129
    v_cvt_pk_bf16_f32 v25, v130, v131
    v_fma_f32 v132, v116, v180, -v176
    v_fma_f32 v133, v117, v181, -v177
    v_fma_f32 v134, v118, v182, -v178
    v_fma_f32 v135, v119, v183, -v179
    v_cvt_pk_bf16_f32 v26, v132, v133
    v_cvt_pk_bf16_f32 v27, v134, v135
    v_fma_f32 v136, v120, v180, -v176
    v_fma_f32 v137, v121, v181, -v177
    v_fma_f32 v138, v122, v182, -v178
    v_fma_f32 v139, v123, v183, -v179
    v_cvt_pk_bf16_f32 v28, v136, v137
    v_cvt_pk_bf16_f32 v29, v138, v139
    v_fma_f32 v140, v124, v180, -v176
    v_fma_f32 v141, v125, v181, -v177
    v_fma_f32 v142, v126, v182, -v178
    v_fma_f32 v143, v127, v183, -v179
    v_cvt_pk_bf16_f32 v30, v140, v141
    v_cvt_pk_bf16_f32 v31, v142, v143
    ds_write_b64 v91, v[24:25] offset:0
    ds_write_b64 v91, v[26:27] offset:4608
    ds_write_b64 v91, v[28:29] offset:9216
    ds_write_b64 v91, v[30:31] offset:13824
    ds_write_b32 v89, v247
    v_mul_f32 v188, 0xbfb8aa3b, v128
    v_mul_f32 v189, 0xbfb8aa3b, v132
    v_mul_f32 v190, 0xbfb8aa3b, v136
    v_mul_f32 v191, 0xbfb8aa3b, v140
    v_exp_f32 v188, v188
    v_exp_f32 v189, v189
    v_exp_f32 v190, v190
    v_exp_f32 v191, v191
    v_add_f32 v188, 1.0, v188
    v_add_f32 v189, 1.0, v189
    v_add_f32 v190, 1.0, v190
    v_add_f32 v191, 1.0, v191
    v_rcp_f32 v188, v188
    v_rcp_f32 v189, v189
    v_rcp_f32 v190, v190
    v_rcp_f32 v191, v191
    v_mul_f32 v128, v128, v188
    v_mul_f32 v132, v132, v189
    v_mul_f32 v136, v136, v190
    v_mul_f32 v140, v140, v191
    v_mul_f32 v188, 0xbfb8aa3b, v129
    v_mul_f32 v189, 0xbfb8aa3b, v133
    v_mul_f32 v190, 0xbfb8aa3b, v137
    v_mul_f32 v191, 0xbfb8aa3b, v141
    v_exp_f32 v188, v188
    v_exp_f32 v189, v189
    v_exp_f32 v190, v190
    v_exp_f32 v191, v191
    v_add_f32 v188, 1.0, v188
    v_add_f32 v189, 1.0, v189
    v_add_f32 v190, 1.0, v190
    v_add_f32 v191, 1.0, v191
    v_rcp_f32 v188, v188
    v_rcp_f32 v189, v189
    v_rcp_f32 v190, v190
    v_rcp_f32 v191, v191
    v_mul_f32 v129, v129, v188
    v_mul_f32 v133, v133, v189
    v_mul_f32 v137, v137, v190
    v_mul_f32 v141, v141, v191
    v_mul_f32 v188, 0xbfb8aa3b, v130
    v_mul_f32 v189, 0xbfb8aa3b, v134
    v_mul_f32 v190, 0xbfb8aa3b, v138
    v_mul_f32 v191, 0xbfb8aa3b, v142
    v_exp_f32 v188, v188
    v_exp_f32 v189, v189
    v_exp_f32 v190, v190
    v_exp_f32 v191, v191
    v_add_f32 v188, 1.0, v188
    v_add_f32 v189, 1.0, v189
    v_add_f32 v190, 1.0, v190
    v_add_f32 v191, 1.0, v191
    v_rcp_f32 v188, v188
    v_rcp_f32 v189, v189
    v_rcp_f32 v190, v190
    v_rcp_f32 v191, v191
    v_mul_f32 v130, v130, v188
    v_mul_f32 v134, v134, v189
    v_mul_f32 v138, v138, v190
    v_mul_f32 v142, v142, v191
    v_mul_f32 v188, 0xbfb8aa3b, v131
    v_mul_f32 v189, 0xbfb8aa3b, v135
    v_mul_f32 v190, 0xbfb8aa3b, v139
    v_mul_f32 v191, 0xbfb8aa3b, v143
    v_exp_f32 v188, v188
    v_exp_f32 v189, v189
    v_exp_f32 v190, v190
    v_exp_f32 v191, v191
    v_add_f32 v188, 1.0, v188
    v_add_f32 v189, 1.0, v189
    v_add_f32 v190, 1.0, v190
    v_add_f32 v191, 1.0, v191
    v_rcp_f32 v188, v188
    v_rcp_f32 v189, v189
    v_rcp_f32 v190, v190
    v_rcp_f32 v191, v191
    v_mul_f32 v131, v131, v188
    v_mul_f32 v135, v135, v189
    v_mul_f32 v139, v139, v190
    v_mul_f32 v143, v143, v191
    s_waitcnt vmcnt(2)
    v_lshlrev_b32 v144, 16, v104
    v_and_b32 v148, 0xffff0000, v104
    v_lshlrev_b32 v152, 16, v105
    v_and_b32 v156, 0xffff0000, v105
    v_lshlrev_b32 v145, 16, v106
    v_and_b32 v149, 0xffff0000, v106
    v_lshlrev_b32 v153, 16, v107
    v_and_b32 v157, 0xffff0000, v107
    v_lshlrev_b32 v146, 16, v108
    v_and_b32 v150, 0xffff0000, v108
    v_lshlrev_b32 v154, 16, v109
    v_and_b32 v158, 0xffff0000, v109
    v_lshlrev_b32 v147, 16, v110
    v_and_b32 v151, 0xffff0000, v110
    v_lshlrev_b32 v155, 16, v111
    v_and_b32 v159, 0xffff0000, v111
    s_mov_b32 s54, 1048576
    s_waitcnt vmcnt(0)
L_g_35:
    v_xor_b32 v2, s4, v17
    v_xor_b32 v3, s4, v19
    v_xor_b32 v5, s4, v21
    v_xor_b32 v6, s4, v23
    v_or3_b32 v2, v2, v3, v5
    v_or_b32 v2, v2, v6
    v_cmp_ne_u32 vcc, 0, v2
    s_cbranch_vccz L_go_36
    s_sub_u32 s54, s54, 1
    s_cbranch_scc1 L_go_36
    global_load_dwordx4 v[16:19], v93, s[42:43] sc1
    global_load_dwordx4 v[20:23], v93, s[42:43] offset:16 sc1
    s_waitcnt vmcnt(0)
    s_branch L_g_35
L_go_36:
    v_and_b32 v180, 0xffff0000, v16
    v_and_b32 v181, 0xffff0000, v18
    v_and_b32 v182, 0xffff0000, v20
    v_and_b32 v183, 0xffff0000, v22
    v_rcp_f32 v180, v180
    v_rcp_f32 v181, v181
    v_rcp_f32 v182, v182
    v_rcp_f32 v183, v183
    v_lshlrev_b32 v176, 16, v16
    v_lshlrev_b32 v177, 16, v18
    v_lshlrev_b32 v178, 16, v20
    v_lshlrev_b32 v179, 16, v22
    v_mul_f32 v176, v176, v180
    v_mul_f32 v177, v177, v181
    v_mul_f32 v178, v178, v182
    v_mul_f32 v179, v179, v183
    v_fma_f32 v160, v144, v180, -v176
    v_fma_f32 v161, v145, v181, -v177
    v_fma_f32 v162, v146, v182, -v178
    v_fma_f32 v163, v147, v183, -v179
    v_cvt_pk_bf16_f32 v32, v160, v161
    v_cvt_pk_bf16_f32 v33, v162, v163
    v_fma_f32 v164, v148, v180, -v176
    v_fma_f32 v165, v149, v181, -v177
    v_fma_f32 v166, v150, v182, -v178
    v_fma_f32 v167, v151, v183, -v179
    v_cvt_pk_bf16_f32 v34, v164, v165
    v_cvt_pk_bf16_f32 v35, v166, v167
    v_fma_f32 v168, v152, v180, -v176
    v_fma_f32 v169, v153, v181, -v177
    v_fma_f32 v170, v154, v182, -v178
    v_fma_f32 v171, v155, v183, -v179
    v_cvt_pk_bf16_f32 v36, v168, v169
    v_cvt_pk_bf16_f32 v37, v170, v171
    v_fma_f32 v172, v156, v180, -v176
    v_fma_f32 v173, v157, v181, -v177
    v_fma_f32 v174, v158, v182, -v178
    v_fma_f32 v175, v159, v183, -v179
    v_cvt_pk_bf16_f32 v38, v172, v173
    v_cvt_pk_bf16_f32 v39, v174, v175
    ds_write_b64 v232, v[32:33] offset:0
    ds_write_b64 v232, v[34:35] offset:4608
    ds_write_b64 v232, v[36:37] offset:9216
    ds_write_b64 v232, v[38:39] offset:13824
    ds_write_b32 v234, v247
    s_cmp_eq_u32 s45, 2
    s_cbranch_scc1 L_pg_38
    s_cmp_eq_u32 s45, 3
    s_cbranch_scc1 L_pg_38
    s_mov_b32 s54, 1048576
L_y_39:
    ds_read_b128 v[192:195], v87 offset:48
    s_sub_u32 s54, s54, 1
    s_cbranch_scc1 L_yo_40
    s_waitcnt lgkmcnt(0)
    v_and_b32 v192, v192, v193
    v_and_b32 v194, v194, v195
    v_and_b32 v192, v192, v194
    s_nop 0
    v_readfirstlane_b32 s5, v192
    s_cmp_lg_u32 s5, 0
    s_cbranch_scc0 L_y_39
L_yo_40:
    global_load_dwordx4 v[40:43], v88, s[42:43] sc1
    ds_read_b128 v[200:203], v90 offset:0
    ds_read_b128 v[204:207], v90 offset:512
    ds_read_b128 v[208:211], v90 offset:1024
    ds_read_b128 v[212:215], v90 offset:1536
    s_waitcnt lgkmcnt(0)
    v_fma_f32 v200, v200, v128, v112
    v_fma_f32 v204, v204, v132, v116
    v_fma_f32 v208, v208, v136, v120
    v_fma_f32 v212, v212, v140, v124
    v_cvt_pk_bf16_f32 v216, v200, v204
    v_cvt_pk_bf16_f32 v217, v208, v212
    global_store_dwordx2 v94, v[216:217], s[40:41] offset:0
    v_fma_f32 v201, v201, v129, v113
    v_fma_f32 v205, v205, v133, v117
    v_fma_f32 v209, v209, v137, v121
    v_fma_f32 v213, v213, v141, v125
    v_cvt_pk_bf16_f32 v218, v201, v205
    v_cvt_pk_bf16_f32 v219, v209, v213
    global_store_dwordx2 v94, v[218:219], s[40:41] offset:1280
    v_fma_f32 v202, v202, v130, v114
    v_fma_f32 v206, v206, v134, v118
    v_fma_f32 v210, v210, v138, v122
    v_fma_f32 v214, v214, v142, v126
    v_cvt_pk_bf16_f32 v220, v202, v206
    v_cvt_pk_bf16_f32 v221, v210, v214
    global_store_dwordx2 v94, v[220:221], s[40:41] offset:2560
    v_fma_f32 v203, v203, v131, v115
    v_fma_f32 v207, v207, v135, v119
    v_fma_f32 v211, v211, v139, v123
    v_fma_f32 v215, v215, v143, v127
    v_cvt_pk_bf16_f32 v222, v203, v207
    v_cvt_pk_bf16_f32 v223, v211, v215
    global_store_dwordx2 v94, v[222:223], s[40:41] offset:3840
    ds_write_b128 v86, v[96:99]
    ds_write_b128 v86, v[100:103] offset:16
    ds_write_b128 v236, v[104:107]
    ds_write_b128 v236, v[108:111] offset:16
    v_mul_f32 v188, 0xbfb8aa3b, v160
    v_mul_f32 v189, 0xbfb8aa3b, v164
    v_mul_f32 v190, 0xbfb8aa3b, v168
    v_mul_f32 v191, 0xbfb8aa3b, v172
    v_exp_f32 v188, v188
    v_exp_f32 v189, v189
    v_exp_f32 v190, v190
    v_exp_f32 v191, v191
    v_add_f32 v188, 1.0, v188
    v_add_f32 v189, 1.0, v189
    v_add_f32 v190, 1.0, v190
    v_add_f32 v191, 1.0, v191
    v_rcp_f32 v188, v188
    v_rcp_f32 v189, v189
    v_rcp_f32 v190, v190
    v_rcp_f32 v191, v191
    v_mul_f32 v160, v160, v188
    v_mul_f32 v164, v164, v189
    v_mul_f32 v168, v168, v190
    v_mul_f32 v172, v172, v191
    v_mul_f32 v188, 0xbfb8aa3b, v161
    v_mul_f32 v189, 0xbfb8aa3b, v165
    v_mul_f32 v190, 0xbfb8aa3b, v169
    v_mul_f32 v191, 0xbfb8aa3b, v173
    v_exp_f32 v188, v188
    v_exp_f32 v189, v189
    v_exp_f32 v190, v190
    v_exp_f32 v191, v191
    v_add_f32 v188, 1.0, v188
    v_add_f32 v189, 1.0, v189
    v_add_f32 v190, 1.0, v190
    v_add_f32 v191, 1.0, v191
    v_rcp_f32 v188, v188
    v_rcp_f32 v189, v189
    v_rcp_f32 v190, v190
    v_rcp_f32 v191, v191
    v_mul_f32 v161, v161, v188
    v_mul_f32 v165, v165, v189
    v_mul_f32 v169, v169, v190
    v_mul_f32 v173, v173, v191
    v_mul_f32 v188, 0xbfb8aa3b, v162
    v_mul_f32 v189, 0xbfb8aa3b, v166
    v_mul_f32 v190, 0xbfb8aa3b, v170
    v_mul_f32 v191, 0xbfb8aa3b, v174
    v_exp_f32 v188, v188
    v_exp_f32 v189, v189
    v_exp_f32 v190, v190
    v_exp_f32 v191, v191
    v_add_f32 v188, 1.0, v188
    v_add_f32 v189, 1.0, v189
    v_add_f32 v190, 1.0, v190
    v_add_f32 v191, 1.0, v191
    v_rcp_f32 v188, v188
    v_rcp_f32 v189, v189
    v_rcp_f32 v190, v190
    v_rcp_f32 v191, v191
    v_mul_f32 v162, v162, v188
    v_mul_f32 v166, v166, v189
    v_mul_f32 v170, v170, v190
    v_mul_f32 v174, v174, v191
    v_mul_f32 v188, 0xbfb8aa3b, v163
    v_mul_f32 v189, 0xbfb8aa3b, v167
    v_mul_f32 v190, 0xbfb8aa3b, v171
    v_mul_f32 v191, 0xbfb8aa3b, v175
    v_exp_f32 v188, v188
    v_exp_f32 v189, v189
    v_exp_f32 v190, v190
    v_exp_f32 v191, v191
    v_add_f32 v188, 1.0, v188
    v_add_f32 v189, 1.0, v189
    v_add_f32 v190, 1.0, v190
    v_add_f32 v191, 1.0, v191
    v_rcp_f32 v188, v188
    v_rcp_f32 v189, v189
    v_rcp_f32 v190, v190
    v_rcp_f32 v191, v191
    v_mul_f32 v163, v163, v188
    v_mul_f32 v167, v167, v189
    v_mul_f32 v171, v171, v190
    v_mul_f32 v175, v175, v191
    s_mov_b32 s54, 1048576
    s_waitcnt vmcnt(4)
L_sel_41:
    v_cmp_ne_u32 vcc, s4, v43
    s_cbranch_vccz L_selo_42
    s_sub_u32 s54, s54, 1
    s_cbranch_scc1 L_selo_42
    global_load_dwordx4 v[40:43], v88, s[42:43] sc1
    s_waitcnt vmcnt(0)
    s_branch L_sel_41
L_selo_42:
    v_and_b32 v44, 0x7ff, v40
    v_sub_u32 v44, 163039, v44
    ds_write_b8 v44, v247
    ds_write_b32 v237, v40 offset:192
    ds_read_b32 v46, v239
    s_waitcnt lgkmcnt(0)
    v_cmp_eq_u32_sdwa s[26:27], v46, 0 src0_sel:BYTE_0 src1_sel:DWORD
    v_cmp_eq_u32_sdwa s[28:29], v46, 0 src0_sel:BYTE_1 src1_sel:DWORD
    v_cmp_eq_u32_sdwa s[30:31], v46, 0 src0_sel:BYTE_2 src1_sel:DWORD
    v_cmp_eq_u32_sdwa s[32:33], v46, 0 src0_sel:BYTE_3 src1_sel:DWORD
    s_waitcnt vmcnt(0)
    ds_write_b32 v89, v247 offset:176
    s_mov_b32 s54, 1048576
L_y_43:
    ds_read_b128 v[192:195], v235 offset:48
    s_sub_u32 s54, s54, 1
    s_cbranch_scc1 L_yo_44
    s_waitcnt lgkmcnt(0)
    v_and_b32 v192, v192, v193
    v_and_b32 v194, v194, v195
    v_and_b32 v192, v192, v194
    s_nop 0
    v_readfirstlane_b32 s5, v192
    s_cmp_lg_u32 s5, 0
    s_cbranch_scc0 L_y_43
L_yo_44:
    ds_read_b128 v[200:203], v233 offset:0
    ds_read_b128 v[204:207], v233 offset:512
    ds_read_b128 v[208:211], v233 offset:1024
    ds_read_b128 v[212:215], v233 offset:1536
    s_waitcnt lgkmcnt(0)
    v_fma_f32 v200, v200, v160, v144
    v_fma_f32 v204, v204, v164, v148
    v_fma_f32 v208, v208, v168, v152
    v_fma_f32 v212, v212, v172, v156
    v_cvt_pk_bf16_f32 v224, v200, v204
    v_cvt_pk_bf16_f32 v225, v208, v212
    s_mov_b64 exec, s[26:27]
    global_store_dwordx2 v95, v[224:225], s[40:41] offset:0
    s_mov_b64 exec, -1
    v_fma_f32 v201, v201, v161, v145
    v_fma_f32 v205, v205, v165, v149
    v_fma_f32 v209, v209, v169, v153
    v_fma_f32 v213, v213, v173, v157
    v_cvt_pk_bf16_f32 v226, v201, v205
    v_cvt_pk_bf16_f32 v227, v209, v213
    s_mov_b64 exec, s[28:29]
    global_store_dwordx2 v95, v[226:227], s[40:41] offset:1280
    s_mov_b64 exec, -1
    v_fma_f32 v202, v202, v162, v146
    v_fma_f32 v206, v206, v166, v150
    v_fma_f32 v210, v210, v170, v154
    v_fma_f32 v214, v214, v174, v158
    v_cvt_pk_bf16_f32 v228, v202, v206
    v_cvt_pk_bf16_f32 v229, v210, v214
    s_mov_b64 exec, s[30:31]
    global_store_dwordx2 v95, v[228:229], s[40:41] offset:2560
    s_mov_b64 exec, -1
    v_fma_f32 v203, v203, v163, v147
    v_fma_f32 v207, v207, v167, v151
    v_fma_f32 v211, v211, v171, v155
    v_fma_f32 v215, v215, v175, v159
    v_cvt_pk_bf16_f32 v230, v203, v207
    v_cvt_pk_bf16_f32 v231, v211, v215
    s_mov_b64 exec, s[32:33]
    global_store_dwordx2 v95, v[230:231], s[40:41] offset:3840
    s_mov_b64 exec, -1
    s_branch L_progend
L_pg_38:
    global_load_dwordx4 v[40:43], v88, s[42:43] sc1
    v_mul_f32 v188, 0xbfb8aa3b, v160
    v_mul_f32 v189, 0xbfb8aa3b, v164
    v_mul_f32 v190, 0xbfb8aa3b, v168
    v_mul_f32 v191, 0xbfb8aa3b, v172
    v_exp_f32 v188, v188
    v_exp_f32 v189, v189
    v_exp_f32 v190, v190
    v_exp_f32 v191, v191
    v_add_f32 v188, 1.0, v188
    v_add_f32 v189, 1.0, v189
    v_add_f32 v190, 1.0, v190
    v_add_f32 v191, 1.0, v191
    v_rcp_f32 v188, v188
    v_rcp_f32 v189, v189
    v_rcp_f32 v190, v190
    v_rcp_f32 v191, v191
    v_mul_f32 v160, v160, v188
    v_mul_f32 v164, v164, v189
    v_mul_f32 v168, v168, v190
    v_mul_f32 v172, v172, v191
    v_mul_f32 v188, 0xbfb8aa3b, v161
    v_mul_f32 v189, 0xbfb8aa3b, v165
    v_mul_f32 v190, 0xbfb8aa3b, v169
    v_mul_f32 v191, 0xbfb8aa3b, v173
    v_exp_f32 v188, v188
    v_exp_f32 v189, v189
    v_exp_f32 v190, v190
    v_exp_f32 v191, v191
    v_add_f32 v188, 1.0, v188
    v_add_f32 v189, 1.0, v189
    v_add_f32 v190, 1.0, v190
    v_add_f32 v191, 1.0, v191
    v_rcp_f32 v188, v188
    v_rcp_f32 v189, v189
    v_rcp_f32 v190, v190
    v_rcp_f32 v191, v191
    v_mul_f32 v161, v161, v188
    v_mul_f32 v165, v165, v189
    v_mul_f32 v169, v169, v190
    v_mul_f32 v173, v173, v191
    v_mul_f32 v188, 0xbfb8aa3b, v162
    v_mul_f32 v189, 0xbfb8aa3b, v166
    v_mul_f32 v190, 0xbfb8aa3b, v170
    v_mul_f32 v191, 0xbfb8aa3b, v174
    v_exp_f32 v188, v188
    v_exp_f32 v189, v189
    v_exp_f32 v190, v190
    v_exp_f32 v191, v191
    v_add_f32 v188, 1.0, v188
    v_add_f32 v189, 1.0, v189
    v_add_f32 v190, 1.0, v190
    v_add_f32 v191, 1.0, v191
    v_rcp_f32 v188, v188
    v_rcp_f32 v189, v189
    v_rcp_f32 v190, v190
    v_rcp_f32 v191, v191
    v_mul_f32 v162, v162, v188
    v_mul_f32 v166, v166, v189
    v_mul_f32 v170, v170, v190
    v_mul_f32 v174, v174, v191
    v_mul_f32 v188, 0xbfb8aa3b, v163
    v_mul_f32 v189, 0xbfb8aa3b, v167
    v_mul_f32 v190, 0xbfb8aa3b, v171
    v_mul_f32 v191, 0xbfb8aa3b, v175
    v_exp_f32 v188, v188
    v_exp_f32 v189, v189
    v_exp_f32 v190, v190
    v_exp_f32 v191, v191
    v_add_f32 v188, 1.0, v188
    v_add_f32 v189, 1.0, v189
    v_add_f32 v190, 1.0, v190
    v_add_f32 v191, 1.0, v191
    v_rcp_f32 v188, v188
    v_rcp_f32 v189, v189
    v_rcp_f32 v190, v190
    v_rcp_f32 v191, v191
    v_mul_f32 v163, v163, v188
    v_mul_f32 v167, v167, v189
    v_mul_f32 v171, v171, v190
    v_mul_f32 v175, v175, v191
    s_mov_b32 s54, 1048576
    s_waitcnt vmcnt(0)
L_sel_45:
    v_cmp_ne_u32 vcc, s4, v43
    s_cbranch_vccz L_selo_46
    s_sub_u32 s54, s54, 1
    s_cbranch_scc1 L_selo_46
    global_load_dwordx4 v[40:43], v88, s[42:43] sc1
    s_waitcnt vmcnt(0)
    s_branch L_sel_45
L_selo_46:
    v_and_b32 v44, 0x7ff, v40
    v_sub_u32 v44, 163039, v44
    ds_write_b8 v44, v247
    ds_write_b32 v237, v40 offset:192
    ds_read_b32 v45, v238
    ds_read_b32 v46, v239
    s_waitcnt lgkmcnt(0)
    v_cmp_eq_u32_sdwa s[18:19], v45, 0 src0_sel:BYTE_0 src1_sel:DWORD
    v_cmp_eq_u32_sdwa s[20:21], v45, 0 src0_sel:BYTE_1 src1_sel:DWORD
    v_cmp_eq_u32_sdwa s[22:23], v45, 0 src0_sel:BYTE_2 src1_sel:DWORD
    v_cmp_eq_u32_sdwa s[24:25], v45, 0 src0_sel:BYTE_3 src1_sel:DWORD
    v_cmp_eq_u32_sdwa s[26:27], v46, 0 src0_sel:BYTE_0 src1_sel:DWORD
    v_cmp_eq_u32_sdwa s[28:29], v46, 0 src0_sel:BYTE_1 src1_sel:DWORD
    v_cmp_eq_u32_sdwa s[30:31], v46, 0 src0_sel:BYTE_2 src1_sel:DWORD
    v_cmp_eq_u32_sdwa s[32:33], v46, 0 src0_sel:BYTE_3 src1_sel:DWORD
    s_mov_b32 s54, 1048576
L_y_47:
    ds_read_b128 v[192:195], v87 offset:48
    s_sub_u32 s54, s54, 1
    s_cbranch_scc1 L_yo_48
    s_waitcnt lgkmcnt(0)
    v_and_b32 v192, v192, v193
    v_and_b32 v194, v194, v195
    v_and_b32 v192, v192, v194
    s_nop 0
    v_readfirstlane_b32 s5, v192
    s_cmp_lg_u32 s5, 0
    s_cbranch_scc0 L_y_47
L_yo_48:
    ds_read_b128 v[200:203], v90 offset:0
    ds_read_b128 v[204:207], v90 offset:512
    ds_read_b128 v[208:211], v90 offset:1024
    ds_read_b128 v[212:215], v90 offset:1536
    s_waitcnt lgkmcnt(0)
    v_fma_f32 v200, v200, v128, v112
    v_fma_f32 v204, v204, v132, v116
    v_fma_f32 v208, v208, v136, v120
    v_fma_f32 v212, v212, v140, v124
    v_cvt_pk_bf16_f32 v216, v200, v204
    v_cvt_pk_bf16_f32 v217, v208, v212
    s_mov_b64 exec, s[18:19]
    global_store_dwordx2 v94, v[216:217], s[40:41] offset:0
    s_mov_b64 exec, -1
    v_fma_f32 v201, v201, v129, v113
    v_fma_f32 v205, v205, v133, v117
    v_fma_f32 v209, v209, v137, v121
    v_fma_f32 v213, v213, v141, v125
    v_cvt_pk_bf16_f32 v218, v201, v205
    v_cvt_pk_bf16_f32 v219, v209, v213
    s_mov_b64 exec, s[20:21]
    global_store_dwordx2 v94, v[218:219], s[40:41] offset:1280
    s_mov_b64 exec, -1
    v_fma_f32 v202, v202, v130, v114
    v_fma_f32 v206, v206, v134, v118
    v_fma_f32 v210, v210, v138, v122
    v_fma_f32 v214, v214, v142, v126
    v_cvt_pk_bf16_f32 v220, v202, v206
    v_cvt_pk_bf16_f32 v221, v210, v214
    s_mov_b64 exec, s[22:23]
    global_store_dwordx2 v94, v[220:221], s[40:41] offset:2560
    s_mov_b64 exec, -1
    v_fma_f32 v203, v203, v131, v115
    v_fma_f32 v207, v207, v135, v119
    v_fma_f32 v211, v211, v139, v123
    v_fma_f32 v215, v215, v143, v127
    v_cvt_pk_bf16_f32 v222, v203, v207
    v_cvt_pk_bf16_f32 v223, v211, v215
    s_mov_b64 exec, s[24:25]
    global_store_dwordx2 v94, v[222:223], s[40:41] offset:3840
    s_mov_b64 exec, -1
    ds_write_b128 v86, v[96:99]
    ds_write_b128 v86, v[100:103] offset:16
    ds_write_b128 v236, v[104:107]
    ds_write_b128 v236, v[108:111] offset:16
    ds_write_b32 v89, v247 offset:176
    s_mov_b32 s54, 1048576
L_y_49:
    ds_read_b128 v[192:195], v235 offset:48
    s_sub_u32 s54, s54, 1
    s_cbranch_scc1 L_yo_50
    s_waitcnt lgkmcnt(0)
    v_and_b32 v192, v192, v193
    v_and_b32 v194, v194, v195
    v_and_b32 v192, v192, v194
    s_nop 0
    v_readfirstlane_b32 s5, v192
    s_cmp_lg_u32 s5, 0
    s_cbranch_scc0 L_y_49
L_yo_50:
    ds_read_b128 v[200:203], v233 offset:0
    ds_read_b128 v[204:207], v233 offset:512
    ds_read_b128 v[208:211], v233 offset:1024
    ds_read_b128 v[212:215], v233 offset:1536
    s_waitcnt lgkmcnt(0)
    v_fma_f32 v200, v200, v160, v144
    v_fma_f32 v204, v204, v164, v148
    v_fma_f32 v208, v208, v168, v152
    v_fma_f32 v212, v212, v172, v156
    v_cvt_pk_bf16_f32 v224, v200, v204
    v_cvt_pk_bf16_f32 v225, v208, v212
    s_mov_b64 exec, s[26:27]
    global_store_dwordx2 v95, v[224:225], s[40:41] offset:0
    s_mov_b64 exec, -1
    v_fma_f32 v201, v201, v161, v145
    v_fma_f32 v205, v205, v165, v149
    v_fma_f32 v209, v209, v169, v153
    v_fma_f32 v213, v213, v173, v157
    v_cvt_pk_bf16_f32 v226, v201, v205
    v_cvt_pk_bf16_f32 v227, v209, v213
    s_mov_b64 exec, s[28:29]
    global_store_dwordx2 v95, v[226:227], s[40:41] offset:1280
    s_mov_b64 exec, -1
    v_fma_f32 v202, v202, v162, v146
    v_fma_f32 v206, v206, v166, v150
    v_fma_f32 v210, v210, v170, v154
    v_fma_f32 v214, v214, v174, v158
    v_cvt_pk_bf16_f32 v228, v202, v206
    v_cvt_pk_bf16_f32 v229, v210, v214
    s_mov_b64 exec, s[30:31]
    global_store_dwordx2 v95, v[228:229], s[40:41] offset:2560
    s_mov_b64 exec, -1
    v_fma_f32 v203, v203, v163, v147
    v_fma_f32 v207, v207, v167, v151
    v_fma_f32 v211, v211, v171, v155
    v_fma_f32 v215, v215, v175, v159
    v_cvt_pk_bf16_f32 v230, v203, v207
    v_cvt_pk_bf16_f32 v231, v211, v215
    s_mov_b64 exec, s[32:33]
    global_store_dwordx2 v95, v[230:231], s[40:41] offset:3840
    s_mov_b64 exec, -1
    s_branch L_progend
L_progend:
    s_endpgm
L_notconv:
    s_sub_u32 s62, s8, 20
    v_lshlrev_b32 v7, 4, v0
    v_add_u32 v7, 135040, v7
    ds_write_b128 v7, v[32:35]
    ds_write_b128 v7, v[32:35] offset:8192
    s_lshr_b32 s63, s62, 1
    s_mov_b64 exec, 0xfffff
    global_load_dword v251, v23, s[56:57]
    s_mov_b64 exec, -1
    s_mov_b64 s[52:53], s[56:57]
    s_lshl_b32 s6, s9, 2
    s_lshr_b32 s6, 0x77777210, s6
    s_and_b32 s6, s6, 7
    s_cmp_ge_u32 s63, 3
    s_cselect_b32 s6, s6, s9
    s_lshl_b32 s48, s63, 3
    s_add_u32 s48, s48, s6
    s_lshl_b32 s48, s48, 1
    s_and_b32 s5, s62, 1
    s_add_u32 s48, s48, s5
    s_mul_i32 s5, s49, 552960
    s_lshl_b32 s6, s48, 6
    s_add_u32 s5, s5, s6
    s_add_u32 s56, s56, s5
    s_addc_u32 s57, s57, 0
    s_mul_i32 s50, s3, 10240
    s_mov_b32 m0, s50
    v_lshrrev_b32 v5, 2, v1
    v_mul_u32_u24 v5, 3456, v5
    v_and_b32 v6, 3, v1
    v_lshl_add_u32 v5, v6, 4, v5
    s_mov_b32 s14, 0x9E3779B1
    s_mov_b32 s47, 0x3f803f80
    s_lshl_b32 s11, s10, 3
    s_sub_u32 s13, 2047, s10
    v_mov_b32 v33, s11
    v_add_u32 v34, 4096, v33
    v_lshlrev_b32 v35, 1, v33
    v_add_u32 v35, 20480, v35
    v_mov_b32 v36, 0x3acccccd
    s_waitcnt vmcnt(2)
    s_setprio 2
    v_dot2_f32_bf16 v24, v8, s47, 0
    v_dot2_f32_bf16 v25, v8, v8, 0
    v_dot2_f32_bf16 v26, v8, v16, 0
    v_dot2_f32_bf16 v27, v16, s47, 0
    v_dot2_f32_bf16 v24, v9, s47, v24
    v_dot2_f32_bf16 v25, v9, v9, v25
    v_dot2_f32_bf16 v26, v9, v17, v26
    v_dot2_f32_bf16 v27, v17, s47, v27
    v_dot2_f32_bf16 v24, v10, s47, v24
    v_dot2_f32_bf16 v25, v10, v10, v25
    v_dot2_f32_bf16 v26, v10, v18, v26
    v_dot2_f32_bf16 v27, v18, s47, v27
    v_dot2_f32_bf16 v24, v11, s47, v24
    v_dot2_f32_bf16 v25, v11, v11, v25
    v_dot2_f32_bf16 v26, v11, v19, v26
    v_dot2_f32_bf16 v27, v19, s47, v27
    v_dot2_f32_bf16 v24, v12, s47, v24
    v_dot2_f32_bf16 v25, v12, v12, v25
    v_dot2_f32_bf16 v26, v12, v20, v26
    v_dot2_f32_bf16 v27, v20, s47, v27
    s_nop 0
    v_permlane32_swap_b32 v24, v25
    s_nop 0
    v_permlane32_swap_b32 v26, v27
    v_add_f32 v24, v24, v25
    v_add_f32 v26, v26, v27
    s_nop 0
    v_mul_lo_u32 v29, v29, s14
    v_permlane16_swap_b32 v24, v26
    v_add_f32 v24, v24, v26
    v_add_u32 v29, 0x7F4A7C15, v29
    v_mov_b32 v31, v29
    v_add_f32_dpp v24, v24, v24 row_shr:1 row_mask:0xf bank_mask:0xf bound_ctrl:0
    v_readfirstlane_b32 s4, v29
    s_nop 0
    v_add_f32_dpp v24, v24, v24 row_shr:2 row_mask:0xf bank_mask:0xf bound_ctrl:0
    s_nop 1
    v_add_f32_dpp v24, v24, v24 row_shr:4 row_mask:0xf bank_mask:0xf bound_ctrl:0
    s_nop 1
    v_add_f32_dpp v24, v24, v24 row_shr:8 row_mask:0xf bank_mask:0xf bound_ctrl:0
    s_mov_b64 exec, 1
    v_readlane_b32 s6, v24, 15
    v_readlane_b32 s7, v24, 47
    v_readlane_b32 s14, v24, 31
    v_readlane_b32 s15, v24, 63
    v_mul_f32 v24, s6, v36
    v_mul_f32 v25, s7, v36
    v_mov_b32 v26, s14
    v_fma_f32 v25, -v24, v24, v25
    v_max_f32 v25, 0, v25
    v_cvt_pk_bf16_f32 v28, v24, v25
    v_and_b32 v25, 0xffff0000, v28
    v_lshlrev_b32 v24, 16, v28
    v_add_f32 v25, 0x3727c5ac, v25
    v_cvt_pk_bf16_f32 v25, v25, v25
    v_fma_f32 v26, -v24, s15, v26
    v_and_b32 v25, 0xffff0000, v25
    v_sqrt_f32 v25, v25
    s_nop 0
    v_cvt_pk_bf16_f32 v28, v24, v25
    v_and_b32 v25, 0xffff0000, v28
    v_rcp_f32 v25, v25
    global_store_dwordx2 v34, v[28:29], s[42:43] sc1
    v_mul_f32 v26, v26, v25
    v_cvt_pk_bf16_f32 v26, v26, v26
    v_ashrrev_i32 v27, 31, v26
    v_or_b32 v27, 0x80000000, v27
    v_xor_b32 v26, v26, v27
    v_and_b32 v26, 0xffff0000, v26
    v_or_b32 v30, s13, v26
    global_store_dwordx4 v35, v[28:31], s[42:43] sc1
    s_mov_b64 exec, -1
    s_setprio 0
    s_waitcnt lgkmcnt(0)
    s_barrier
    s_mov_b64 exec, -1
    s_cmp_lt_u32 s48, 54
    s_cbranch_scc1 L_moe
    s_cmp_lt_u32 s62, 8
    s_cbranch_scc1 L_fin
    s_sub_u32 s63, s62, 8
    s_cmp_eq_u32 s2, 255
    s_cbranch_scc1 L_selector
    s_lshl_b32 s6, s9, 2
    s_lshr_b32 s6, 0x77777210, s6
    s_and_b32 s6, s6, 7
    s_cmp_ge_u32 s63, 3
    s_cselect_b32 s6, s6, s9
    s_lshl_b32 s5, s63, 3
    s_add_u32 s5, s5, s6
    s_cmp_ge_u32 s5, 27
    s_cbranch_scc1 L_fin
    s_mul_i32 s5, s5, 81920
    s_add_u32 s5, s5, s50
    v_lshl_add_u32 v5, v1, 7, s5
    global_load_dword v251, v5, s[38:39]
    v_add_u32 v5, 8192, v5
    s_mov_b64 exec, 0xffff
    global_load_dword v251, v5, s[38:39]
    s_mov_b64 exec, -1
L_idle:
    s_branch L_fin
L_moe:
    v_and_b32 v116, 15, v1
    v_lshrrev_b32 v117, 4, v1
    s_mul_i32 s5, s48, 40960
    s_lshl_b32 s6, s3, 8
    s_add_u32 s5, s5, s6
    v_mul_u32_u24 v34, 10240, v117
    v_lshl_add_u32 v34, v116, 4, v34
    v_add_u32 v34, s5, v34
    v_add_u32 v35, 5120, v34
    global_load_lds_dwordx4 v5, s[56:57]
    s_add_u32 m0, m0, 1024
    s_add_u32 s56, s56, 55296
    s_addc_u32 s57, s57, 0
    global_load_lds_dwordx4 v5, s[56:57]
    s_add_u32 m0, m0, 1024
    s_add_u32 s56, s56, 55296
    s_addc_u32 s57, s57, 0
    global_load_lds_dwordx4 v5, s[56:57]
    s_add_u32 m0, m0, 1024
    s_add_u32 s56, s56, 55296
    s_addc_u32 s57, s57, 0
    global_load_lds_dwordx4 v5, s[56:57]
    s_add_u32 m0, m0, 1024
    s_add_u32 s56, s56, 55296
    s_addc_u32 s57, s57, 0
    global_load_lds_dwordx4 v5, s[56:57]
    s_add_u32 m0, m0, 1024
    s_add_u32 s56, s56, 55296
    s_addc_u32 s57, s57, 0
    global_load_lds_dwordx4 v5, s[56:57]
    s_add_u32 m0, m0, 1024
    s_add_u32 s56, s56, 55296
    s_addc_u32 s57, s57, 0
    global_load_lds_dwordx4 v5, s[56:57]
    s_add_u32 m0, m0, 1024
    s_add_u32 s56, s56, 55296
    s_addc_u32 s57, s57, 0
    global_load_lds_dwordx4 v5, s[56:57]
    s_add_u32 m0, m0, 1024
    s_add_u32 s56, s56, 55296
    s_addc_u32 s57, s57, 0
    global_load_lds_dwordx4 v5, s[56:57]
    s_add_u32 m0, m0, 1024
    s_add_u32 s56, s56, 55296
    s_addc_u32 s57, s57, 0
    global_load_lds_dwordx4 v5, s[56:57]
    v_and_b32 v39, 7, v1
    s_lshl_b32 s5, s9, 7
    s_add_u32 s5, s5, 53248
    v_lshl_add_u32 v36, v39, 4, s5
    s_mov_b32 s60, 0x05040100
    s_mov_b32 s61, 0x07060302
    v_mov_b32 v112, 0x3f803f80
    v_mov_b32 v113, 0x3f803f80
    v_mov_b32 v114, 0x3f803f80
    v_mov_b32 v115, 0x3f803f80
    s_mov_b32 s62, 0x00ff00ff
    s_mov_b32 s63, 0x00ff00ff
    v_lshlrev_b32 v7, 9, v117
    v_bfe_u32 v38, v1, 2, 2
    v_lshl_add_u32 v7, v38, 6, v7
    v_and_b32 v38, 1, v1
    v_lshl_add_u32 v7, v38, 3, v7
    v_bfe_u32 v38, v1, 1, 1
    v_mul_u32_u24 v38, 10240, v38
    s_lshl_b32 s5, s45, 4
    v_add3_u32 v7, v7, v38, s5
    v_add_u32 v37, 40960, v7
    v_lshlrev_b32 v118, 4, v1
    v_lshlrev_b32 v204, 6, v39
    v_and_b32 v38, 1, v117
    v_lshl_add_u32 v204, v38, 3, v204
    v_lshrrev_b32 v38, 1, v117
    v_lshl_add_u32 v204, v38, 2, v204
    s_add_u32 s5, s5, 126352
    v_add_u32 v204, s5, v204
    v_lshlrev_b32 v206, 6, v39
    v_lshl_add_u32 v206, v117, 4, v206
    v_add_u32 v206, 126352, v206
    v_mov_b32 v207, 135104
    v_cndmask_b32 v208, v207, v206, s[62:63]
    v_cndmask_b32 v207, v206, v207, s[62:63]
    s_and_b32 s5, s4, 0xff
    v_mov_b32 v212, s5
    s_bfe_u32 s5, s4, 0x80008
    v_mov_b32 v213, s5
    s_bfe_u32 s5, s4, 0x80010
    v_mov_b32 v214, s5
    s_lshr_b32 s5, s4, 24
    v_mov_b32 v215, s5
    v_bfe_u32 v216, v1, 3, 1
    v_lshl_add_u32 v216, v117, 3, v216
    v_mul_u32_u24 v216, 7168, v216
    v_lshl_add_u32 v216, v39, 4, v216
    s_mul_i32 s5, s3, 229376
    s_lshl_b32 s6, s48, 7
    s_add_u32 s5, s5, s6
    s_add_u32 s5, s5, 65536
    v_add_u32 v216, s5, v216
    v_add_u32 v217, 14336, v216
    v_add_u32 v218, 28672, v216
    v_add_u32 v219, 43008, v216
    v_min_u32 v220, 8, v116
    v_mul_u32_u24 v220, 1296, v220
    v_lshl_add_u32 v220, v117, 4, v220
    v_add_u32 v220, 114688, v220
    s_mul_i32 s55, s45, 1296
    s_add_u32 s55, s55, 114688
    s_add_u32 s47, s45, 4
    v_min_u32 v38, 79, v0
    v_lshlrev_b32 v38, 4, v38
    v_add_u32 v38, 125056, v38
    ds_write_b128 v38, v[112:115]
    s_waitcnt vmcnt(0)
    s_cmp_ge_u32 s3, 5
    s_cbranch_scc1 L_nod
L_nod:
    global_load_dwordx4 v[8:11], v36, s[42:43] sc1
    s_barrier
    s_cmp_ge_u32 s3, 5
    s_cbranch_scc1 L_nod0
    global_load_dwordx4 v[80:83], v34, s[38:39] offset:0
    global_load_dwordx4 v[84:87], v34, s[38:39] offset:1280
    global_load_dwordx4 v[88:91], v34, s[38:39] offset:2560
    global_load_dwordx4 v[92:95], v34, s[38:39] offset:3840
    global_load_dwordx4 v[96:99], v35, s[38:39] offset:0
    global_load_dwordx4 v[100:103], v35, s[38:39] offset:1280
    global_load_dwordx4 v[104:107], v35, s[38:39] offset:2560
    global_load_dwordx4 v[108:111], v35, s[38:39] offset:3840
L_nod0:
    s_cmp_ge_u32 s3, 4
    s_cbranch_scc1 L_nocs
    ds_read_b64_tr_b16 v[120:121], v7 offset:0
    ds_read_b64_tr_b16 v[122:123], v7 offset:256
    ds_read_b64_tr_b16 v[124:125], v7 offset:2048
    ds_read_b64_tr_b16 v[126:127], v7 offset:2304
    ds_read_b64_tr_b16 v[128:129], v7 offset:4096
    ds_read_b64_tr_b16 v[130:131], v7 offset:4352
    ds_read_b64_tr_b16 v[132:133], v7 offset:6144
    ds_read_b64_tr_b16 v[134:135], v7 offset:6400
    ds_read_b64_tr_b16 v[136:137], v7 offset:8192
    ds_read_b64_tr_b16 v[138:139], v7 offset:8448
    ds_read_b64_tr_b16 v[140:141], v7 offset:20480
    ds_read_b64_tr_b16 v[142:143], v7 offset:20736
    ds_read_b64_tr_b16 v[144:145], v7 offset:22528
    ds_read_b64_tr_b16 v[146:147], v7 offset:22784
    ds_read_b64_tr_b16 v[148:149], v7 offset:24576
    ds_read_b64_tr_b16 v[150:151], v7 offset:24832
    ds_read_b64_tr_b16 v[152:153], v7 offset:26624
    ds_read_b64_tr_b16 v[154:155], v7 offset:26880
    ds_read_b64_tr_b16 v[156:157], v7 offset:28672
    ds_read_b64_tr_b16 v[158:159], v7 offset:28928
    ds_read_b64_tr_b16 v[160:161], v37 offset:0
    ds_read_b64_tr_b16 v[162:163], v37 offset:256
    ds_read_b64_tr_b16 v[164:165], v37 offset:2048
    ds_read_b64_tr_b16 v[166:167], v37 offset:2304
    ds_read_b64_tr_b16 v[168:169], v37 offset:4096
    ds_read_b64_tr_b16 v[170:171], v37 offset:4352
    ds_read_b64_tr_b16 v[172:173], v37 offset:6144
    ds_read_b64_tr_b16 v[174:175], v37 offset:6400
    ds_read_b64_tr_b16 v[176:177], v37 offset:8192
    ds_read_b64_tr_b16 v[178:179], v37 offset:8448
    ds_read_b64_tr_b16 v[180:181], v37 offset:20480
    ds_read_b64_tr_b16 v[182:183], v37 offset:20736
    ds_read_b64_tr_b16 v[184:185], v37 offset:22528
    ds_read_b64_tr_b16 v[186:187], v37 offset:22784
    ds_read_b64_tr_b16 v[188:189], v37 offset:24576
    ds_read_b64_tr_b16 v[190:191], v37 offset:24832
    ds_read_b64_tr_b16 v[192:193], v37 offset:26624
    ds_read_b64_tr_b16 v[194:195], v37 offset:26880
    ds_read_b64_tr_b16 v[196:197], v37 offset:28672
    ds_read_b64_tr_b16 v[198:199], v37 offset:28928
L_nocs:
    s_mov_b32 s54, 1048576
    s_mov_b32 m0, s55
    s_waitcnt vmcnt(0)
L_msel_51:
    v_cmp_ne_u32 vcc, s4, v11
    s_cbranch_vccz L_mselo_52
    s_sub_u32 s54, s54, 1
    s_cbranch_scc1 L_mselo_52
    global_load_dwordx4 v[8:11], v36, s[42:43] sc1
    s_waitcnt vmcnt(0)
    s_branch L_msel_51
L_mselo_52:
    s_cmp_lt_u32 s3, 4
    s_cbranch_scc1 L_norow
    v_readlane_b32 s52, v8, s45
    v_readlane_b32 s53, v8, s47
    s_and_b32 s52, s52, 0x7ff
    s_and_b32 s53, s53, 0x7ff
    s_sub_u32 s52, 2047, s52
    s_sub_u32 s53, 2047, s53
    s_mul_i32 s52, s52, 1280
    s_mul_i32 s53, s53, 1280
    s_add_u32 s56, s16, s52
    s_addc_u32 s57, s17, 0
    s_add_u32 s58, s16, s53
    s_addc_u32 s59, s17, 0
    global_load_lds_dwordx4 v118, s[56:57]
    global_load_lds_dword v4, s[56:57] offset:1024
    s_add_u32 m0, m0, 5184
    s_nop 0
    global_load_lds_dwordx4 v118, s[58:59]
    global_load_lds_dword v4, s[58:59] offset:1024
L_norow:
    v_perm_b32 v224, v84, v80, s60
    v_perm_b32 v225, v92, v88, s60
    v_perm_b32 v226, v100, v96, s60
    v_perm_b32 v227, v108, v104, s60
    v_perm_b32 v228, v84, v80, s61
    v_perm_b32 v229, v92, v88, s61
    v_perm_b32 v230, v100, v96, s61
    v_perm_b32 v231, v108, v104, s61
    v_perm_b32 v232, v85, v81, s60
    v_perm_b32 v233, v93, v89, s60
    v_perm_b32 v234, v101, v97, s60
    v_perm_b32 v235, v109, v105, s60
    v_perm_b32 v236, v85, v81, s61
    v_perm_b32 v237, v93, v89, s61
    v_perm_b32 v238, v101, v97, s61
    v_perm_b32 v239, v109, v105, s61
    v_perm_b32 v240, v86, v82, s60
    v_perm_b32 v241, v94, v90, s60
    v_perm_b32 v242, v102, v98, s60
    v_perm_b32 v243, v110, v106, s60
    v_perm_b32 v244, v86, v82, s61
    v_perm_b32 v245, v94, v90, s61
    v_perm_b32 v246, v102, v98, s61
    v_perm_b32 v247, v110, v106, s61
    v_perm_b32 v248, v87, v83, s60
    v_perm_b32 v249, v95, v91, s60
    v_perm_b32 v250, v103, v99, s60
    v_perm_b32 v251, v111, v107, s60
    v_perm_b32 v252, v87, v83, s61
    v_perm_b32 v253, v95, v91, s61
    v_perm_b32 v254, v103, v99, s61
    v_perm_b32 v255, v111, v107, s61
    s_mov_b32 s59, 0xffffff00
    v_and_b32 v33, 0xffff0000, v9
    v_lshlrev_b32 v32, 16, v9
    v_rcp_f32 v33, v33
    v_xor_b32 v32, 0x80000000, v32
    v_mul_f32 v30, 0xbfb8aa3b, v33
    v_mul_f32 v31, v33, v33
    s_waitcnt vmcnt(0) lgkmcnt(0)
    s_barrier
    s_cmp_ge_u32 s3, 4
    s_cbranch_scc1 L_nored
    ds_read_b128 v[40:43], v220 offset:0
    ds_read_b128 v[44:47], v220 offset:64
    ds_read_b128 v[48:51], v220 offset:128
    ds_read_b128 v[52:55], v220 offset:192
    ds_read_b128 v[56:59], v220 offset:256
    ds_read_b128 v[12:15], v220 offset:320
    ds_read_b128 v[16:19], v220 offset:384
    s_waitcnt lgkmcnt(6)
    v_mfma_f32_16x16x32_bf16 v[60:63], v[120:123], v[40:43], 0
    ds_read_b128 v[20:23], v220 offset:448
    s_waitcnt lgkmcnt(6)
    v_mfma_f32_16x16x32_bf16 v[60:63], v[124:127], v[44:47], v[60:63]
    ds_read_b128 v[40:43], v220 offset:512
    s_waitcnt lgkmcnt(6)
    v_mfma_f32_16x16x32_bf16 v[60:63], v[128:131], v[48:51], v[60:63]
    ds_read_b128 v[44:47], v220 offset:576
    s_waitcnt lgkmcnt(6)
    v_mfma_f32_16x16x32_bf16 v[60:63], v[132:135], v[52:55], v[60:63]
    ds_read_b128 v[48:51], v220 offset:640
    s_waitcnt lgkmcnt(6)
    v_mfma_f32_16x16x32_bf16 v[60:63], v[136:139], v[56:59], v[60:63]
    ds_read_b128 v[52:55], v220 offset:704
    s_waitcnt lgkmcnt(6)
    v_mfma_f32_16x16x32_bf16 v[60:63], v[140:143], v[12:15], v[60:63]
    ds_read_b128 v[56:59], v220 offset:768
    s_waitcnt lgkmcnt(6)
    v_mfma_f32_16x16x32_bf16 v[60:63], v[144:147], v[16:19], v[60:63]
    ds_read_b128 v[12:15], v220 offset:832
    s_waitcnt lgkmcnt(6)
    v_mfma_f32_16x16x32_bf16 v[60:63], v[148:151], v[20:23], v[60:63]
    ds_read_b128 v[16:19], v220 offset:896
    s_waitcnt lgkmcnt(6)
    v_mfma_f32_16x16x32_bf16 v[60:63], v[152:155], v[40:43], v[60:63]
    ds_read_b128 v[20:23], v220 offset:960
    s_waitcnt lgkmcnt(6)
    v_mfma_f32_16x16x32_bf16 v[60:63], v[156:159], v[44:47], v[60:63]
    ds_read_b128 v[40:43], v220 offset:1024
    s_waitcnt lgkmcnt(6)
    v_mfma_f32_16x16x32_bf16 v[60:63], v[160:163], v[48:51], v[60:63]
    ds_read_b128 v[44:47], v220 offset:1088
    s_waitcnt lgkmcnt(6)
    v_mfma_f32_16x16x32_bf16 v[60:63], v[164:167], v[52:55], v[60:63]
    ds_read_b128 v[48:51], v220 offset:1152
    s_waitcnt lgkmcnt(6)
    v_mfma_f32_16x16x32_bf16 v[60:63], v[168:171], v[56:59], v[60:63]
    ds_read_b128 v[52:55], v220 offset:1216
    s_waitcnt lgkmcnt(6)
    v_mfma_f32_16x16x32_bf16 v[60:63], v[172:175], v[12:15], v[60:63]
    s_waitcnt lgkmcnt(5)
    v_mfma_f32_16x16x32_bf16 v[60:63], v[176:179], v[16:19], v[60:63]
    s_waitcnt lgkmcnt(4)
    v_mfma_f32_16x16x32_bf16 v[60:63], v[180:183], v[20:23], v[60:63]
    s_waitcnt lgkmcnt(3)
    v_mfma_f32_16x16x32_bf16 v[60:63], v[184:187], v[40:43], v[60:63]
    s_waitcnt lgkmcnt(2)
    v_mfma_f32_16x16x32_bf16 v[60:63], v[188:191], v[44:47], v[60:63]
    s_waitcnt lgkmcnt(1)
    v_mfma_f32_16x16x32_bf16 v[60:63], v[192:195], v[48:51], v[60:63]
    s_waitcnt lgkmcnt(0)
    v_mfma_f32_16x16x32_bf16 v[60:63], v[196:199], v[52:55], v[60:63]
    s_nop 7
    v_fmac_f32_dpp v60, v60, v32 row_ror:8 row_mask:0xf bank_mask:0xf
    v_fmac_f32_dpp v62, v62, v32 row_ror:8 row_mask:0xf bank_mask:0xf
    v_fmac_f32_dpp v61, v61, v32 row_ror:8 row_mask:0xf bank_mask:0xf
    v_fmac_f32_dpp v63, v63, v32 row_ror:8 row_mask:0xf bank_mask:0xf
    v_permlane32_swap_b32 v60, v62
    s_nop 0
    v_permlane32_swap_b32 v61, v63
    v_mul_f32 v8, v60, v30
    v_mul_f32 v9, v61, v30
    v_exp_f32 v8, v8
    v_exp_f32 v9, v9
    v_mul_f32 v60, v60, v62
    v_mul_f32 v61, v61, v63
    v_add_f32 v8, 1.0, v8
    v_add_f32 v9, 1.0, v9
    v_rcp_f32 v8, v8
    v_rcp_f32 v9, v9
    v_mul_f32 v60, v60, v31
    v_mul_f32 v61, v61, v31
    v_mul_f32 v60, v60, v8
    v_mul_f32 v61, v61, v9
    s_mov_b64 exec, s[62:63]
    v_cvt_pk_bf16_f32 v8, v60, v61
    ds_write_b32 v204, v8
    s_mov_b64 exec, -1
L_nored:
    s_waitcnt lgkmcnt(0)
    s_barrier
    s_cmp_ge_u32 s3, 5
    s_cbranch_scc1 L_fin
    ds_read_b128 v[8:11], v208
    ds_read_b128 v[12:15], v207
    s_waitcnt lgkmcnt(1)
    v_mfma_f32_16x16x32_bf16 v[56:59], v[224:227], v[8:11], 0
    v_mfma_f32_16x16x32_bf16 v[60:63], v[228:231], v[8:11], 0
    v_mfma_f32_16x16x32_bf16 v[64:67], v[232:235], v[8:11], 0
    v_mfma_f32_16x16x32_bf16 v[68:71], v[236:239], v[8:11], 0
    s_waitcnt lgkmcnt(0)
    v_mfma_f32_16x16x32_bf16 v[56:59], v[240:243], v[12:15], v[56:59]
    v_mfma_f32_16x16x32_bf16 v[60:63], v[244:247], v[12:15], v[60:63]
    v_mfma_f32_16x16x32_bf16 v[64:67], v[248:251], v[12:15], v[64:67]
    v_mfma_f32_16x16x32_bf16 v[68:71], v[252:255], v[12:15], v[68:71]
    s_nop 4
    v_bfi_b32 v72, s59, v56, v212
    v_bfi_b32 v73, s59, v60, v213
    v_bfi_b32 v74, s59, v64, v214
    v_bfi_b32 v75, s59, v68, v215
    global_store_dwordx4 v216, v[72:75], s[42:43] sc1
    v_bfi_b32 v76, s59, v57, v212
    v_bfi_b32 v77, s59, v61, v213
    v_bfi_b32 v78, s59, v65, v214
    v_bfi_b32 v79, s59, v69, v215
    global_store_dwordx4 v217, v[76:79], s[42:43] sc1
    v_bfi_b32 v80, s59, v58, v212
    v_bfi_b32 v81, s59, v62, v213
    v_bfi_b32 v82, s59, v66, v214
    v_bfi_b32 v83, s59, v70, v215
    global_store_dwordx4 v218, v[80:83], s[42:43] sc1
    v_bfi_b32 v84, s59, v59, v212
    v_bfi_b32 v85, s59, v63, v213
    v_bfi_b32 v86, s59, v67, v214
    v_bfi_b32 v87, s59, v71, v215
    global_store_dwordx4 v219, v[84:87], s[42:43] sc1
    s_endpgm
L_selector:
    v_and_b32 v116, 15, v1
    v_lshrrev_b32 v117, 4, v1
    s_lshl_b32 s5, s3, 12
    s_add_u32 s5, s5, 20480
    v_lshl_add_u32 v36, v1, 4, s5
    v_lshlrev_b32 v221, 2, v116
    v_lshlrev_b32 v222, 4, v117
    v_add_u32 v223, 126864, v221
    v_add_u32 v224, 126864, v222
    v_add_u32 v221, 148352, v221
    v_add_u32 v222, 148352, v222
    v_lshrrev_b32 v225, 5, v0
    v_lshlrev_b32 v225, 2, v225
    v_add_u32 v225, 126864, v225
    v_mov_b32 v19, 147328
    v_lshlrev_b32 v40, 8, v117
    v_add_u32 v40, 53248, v40
    v_mov_b32 v41, 0
    v_mov_b32 v46, s4
    v_mov_b32 v47, s4
    s_lshl_b32 s5, s3, 10
    s_sub_u32 s5, 7420, s5
    v_sub_u32 v37, s5, v4
    v_bfrev_b32 v50, v0
    v_mov_b32 v54, 0
    v_mov_b32 v58, 0
    v_mov_b32 v62, 0
    s_mov_b32 s59, 0
L_s_real:
    v_subrev_u32 v221, 12288, v221
    v_subrev_u32 v222, 12288, v222
    v_subrev_u32 v19, 12288, v19
    s_mov_b32 s59, 1
    s_mov_b32 s54, 1048576
L_s_poll:
    global_load_dwordx4 v[48:51], v36, s[42:43] offset:0 sc1
    global_load_dwordx4 v[52:55], v36, s[42:43] offset:1024 sc1
    global_load_dwordx4 v[56:59], v36, s[42:43] offset:2048 sc1
    global_load_dwordx4 v[60:63], v36, s[42:43] offset:3072 sc1
    s_sub_u32 s54, s54, 1
    s_cbranch_scc1 L_s_top
    s_waitcnt vmcnt(0)
    v_xor_b32 v2, s4, v51
    v_xor_b32 v3, s4, v55
    v_xor_b32 v5, s4, v59
    v_xor_b32 v6, s4, v63
    v_or3_b32 v2, v2, v3, v5
    v_or_b32 v2, v2, v6
    v_cmp_ne_u32 vcc, 0, v2
    s_cbranch_vccnz L_s_poll
L_s_top:
    v_max3_u32 v16, v50, v54, v58
    v_max_u32 v16, v16, v62
    s_nop 1
    v_max_u32_dpp v16, v16, v16 row_shr:1 row_mask:0xf bank_mask:0xf
    s_nop 1
    v_max_u32_dpp v16, v16, v16 row_shr:2 row_mask:0xf bank_mask:0xf
    s_nop 1
    v_max_u32_dpp v16, v16, v16 row_shr:4 row_mask:0xf bank_mask:0xf
    s_nop 1
    v_max_u32_dpp v16, v16, v16 row_shr:8 row_mask:0xf bank_mask:0xf
    s_nop 1
    v_max_u32_dpp v16, v16, v16 row_bcast:15 row_mask:0xa bank_mask:0xf
    s_mov_b32 exec_lo, 0x80000000
    s_mov_b32 exec_hi, 0x80000000
    ds_write_b32 v225, v16
    s_mov_b64 exec, -1
    s_waitcnt lgkmcnt(0)
    s_barrier
    ds_read_b32 v17, v223
    ds_read_b128 v[20:23], v224
    ds_write2st64_b32 v37, v60, v56 offset0:0 offset1:1
    ds_write2st64_b32 v37, v52, v48 offset0:2 offset1:3
    s_waitcnt lgkmcnt(2)
    v_cmp_gt_u32 s[6:7], v20, v17
    v_cmp_gt_u32 s[10:11], v21, v17
    v_cmp_gt_u32 s[12:13], v22, v17
    v_cmp_gt_u32 s[14:15], v23, v17
    v_addc_co_u32_e64 v18, vcc, 0, 0, s[6:7]
    v_addc_co_u32_e64 v18, vcc, v18, 0, s[10:11]
    v_addc_co_u32_e64 v18, vcc, v18, 0, s[12:13]
    v_addc_co_u32_e64 v18, vcc, v18, 0, s[14:15]
    v_mov_b32 v24, v18
    s_nop 1
    v_permlane16_swap_b32 v18, v24
    v_add_u32 v18, v18, v24
    v_mov_b32 v24, v18
    s_nop 1
    v_permlane32_swap_b32 v18, v24
    v_add_u32 v18, v18, v24
    v_cmp_eq_u32 vcc, 7, v18
    s_ff1_i32_b64 s5, vcc
    v_readlane_b32 s5, v17, s5
    s_nop 1
    v_cmp_le_u32 s[6:7], s5, v50
    v_cmp_le_u32 s[10:11], s5, v54
    v_cmp_le_u32 s[12:13], s5, v58
    v_cmp_le_u32 s[14:15], s5, v62
    v_addc_co_u32_e64 v21, vcc, 0, 0, s[6:7]
    s_or_b64 s[50:51], s[6:7], s[10:11]
    v_addc_co_u32_e64 v22, vcc, v21, 0, s[10:11]
    s_or_b64 s[52:53], s[12:13], s[14:15]
    v_addc_co_u32_e64 v23, vcc, v22, 0, s[12:13]
    s_or_b64 exec, s[50:51], s[52:53]
    v_addc_co_u32_e64 v24, vcc, v23, 0, s[14:15]
    ds_add_rtn_u32 v25, v19, v24
    s_waitcnt lgkmcnt(0)
    v_lshl_add_u32 v25, v25, 2, v19
    v_lshl_add_u32 v21, v21, 2, v25
    v_lshl_add_u32 v22, v22, 2, v25
    v_lshl_add_u32 v23, v23, 2, v25
    s_mov_b64 exec, s[6:7]
    ds_write_b32 v25, v50 offset:1024
    s_mov_b64 exec, s[10:11]
    ds_write_b32 v21, v54 offset:1024
    s_mov_b64 exec, s[12:13]
    ds_write_b32 v22, v58 offset:1024
    s_mov_b64 exec, s[14:15]
    ds_write_b32 v23, v62 offset:1024
    s_mov_b64 exec, -1
    s_waitcnt lgkmcnt(0)
    s_barrier
    s_cmp_lg_u32 s3, 0
    s_cbranch_scc1 L_fin
    ds_read_b32 v28, v19
    ds_read_b32 v17, v221
    ds_read_b128 v[20:23], v222
    s_waitcnt lgkmcnt(1)
    v_readfirstlane_b32 s51, v28
    s_cmp_gt_u32 s51, 16
    s_cbranch_scc1 L_rk_many
L_rk_done:
    v_and_b32 v14, 0x7ff, v17
    v_lshlrev_b32 v14, 2, v14
    ds_read_b32 v45, v14 offset:0
    s_waitcnt lgkmcnt(1)
    v_cmp_gt_u32 s[6:7], v20, v17
    v_cmp_gt_u32 s[10:11], v21, v17
    v_cmp_gt_u32 s[12:13], v22, v17
    v_cmp_gt_u32 s[14:15], v23, v17
    v_addc_co_u32_e64 v18, vcc, 0, 0, s[6:7]
    v_addc_co_u32_e64 v18, vcc, v18, 0, s[10:11]
    v_addc_co_u32_e64 v18, vcc, v18, 0, s[12:13]
    v_addc_co_u32_e64 v18, vcc, v18, 0, s[14:15]
    v_mov_b32 v24, v18
    s_nop 1
    v_permlane16_swap_b32 v18, v24
    v_add_u32 v18, v18, v24
    v_mov_b32 v24, v18
    s_nop 1
    v_permlane32_swap_b32 v18, v24
    v_add_u32 v18, v18, v24
    v_cmp_gt_u32 vcc, 8, v18
    v_lshl_add_u32 v18, v18, 4, v40
    v_mov_b32 v44, v17
    s_cmp_eq_u32 s59, 0
    s_cbranch_scc1 L_s_real
    s_cmp_lg_u32 s3, 0
    s_cbranch_scc1 L_fin
    s_mov_b64 exec, vcc
    s_waitcnt lgkmcnt(0)
    global_store_dwordx4 v18, v[44:47], s[42:43] sc1
    global_store_dwordx4 v18, v[44:47], s[42:43] offset:128 sc1
    s_mov_b64 exec, 1
    global_store_dword v41, v46, s[42:43] sc1
    s_branch L_fin
L_rk_many:
    v_lshl_add_u32 v26, v1, 2, v19
    v_mov_b32 v27, v1
    s_lshl_b32 s5, s3, 6
    s_add_u32 s58, s5, 135168
    s_mov_b32 s50, 0
L_rk_outer:
    ds_read_b32 v29, v26 offset:1024
    v_mov_b32 v30, 0
    v_mov_b32 v31, v19
    s_mov_b32 s52, 0
L_rk_inner:
    ds_read_b128 v[8:11], v31 offset:1024
    v_add_u32 v31, 16, v31
    s_add_u32 s52, s52, 4
    s_waitcnt lgkmcnt(0)
    v_cmp_gt_u32 s[6:7], v8, v29
    v_cmp_gt_u32 s[10:11], v9, v29
    v_cmp_gt_u32 s[12:13], v10, v29
    v_cmp_gt_u32 s[14:15], v11, v29
    v_addc_co_u32_e64 v30, vcc, v30, 0, s[6:7]
    v_addc_co_u32_e64 v30, vcc, v30, 0, s[10:11]
    v_addc_co_u32_e64 v30, vcc, v30, 0, s[12:13]
    v_addc_co_u32_e64 v30, vcc, v30, 0, s[14:15]
    s_cmp_lt_u32 s52, s51
    s_cbranch_scc1 L_rk_inner
    v_cmp_gt_u32 s[6:7], 8, v30
    v_cmp_gt_u32 s[10:11], s51, v27
    v_lshl_add_u32 v30, v30, 2, s58
    s_and_b64 exec, s[6:7], s[10:11]
    ds_write_b32 v30, v29
    s_mov_b64 exec, -1
    v_add_u32 v26, 256, v26
    v_add_u32 v27, 64, v27
    s_add_u32 s50, s50, 64
    s_cmp_lt_u32 s50, s51
    s_cbranch_scc1 L_rk_outer
    v_lshl_add_u32 v26, v116, 2, s58
    v_lshl_add_u32 v27, v117, 4, s58
    ds_read_b32 v17, v26
    ds_read_b128 v[20:23], v27
    s_waitcnt lgkmcnt(0)
    s_branch L_rk_done
L_fin:
    s_endpgm
L_end:
    s_endpgm
L_code_end:
.fill 64, 4, 0xBF800000

.section .rodata,"a"
.p2align 6
.amdhsa_kernel recurrent_scan__ssm_conv_s4d__moe_arch_mod__prompt_kernel
  .amdhsa_next_free_vgpr 256
  .amdhsa_next_free_sgpr 96
  .amdhsa_accum_offset 256
  .amdhsa_group_segment_fixed_size 0
  .amdhsa_kernarg_size 120
  .amdhsa_user_sgpr_count 2
  .amdhsa_user_sgpr_kernarg_segment_ptr 1
  .amdhsa_system_sgpr_workgroup_id_x 1
.end_amdhsa_kernel
```
